```python
import torch

def _softmax(x, axis=-1):
    return torch.softmax(x, dim=axis)
def _gelu(x):
    return torch.nn.functional.gelu(x, approximate="tanh")
def _silu(x):
    return torch.nn.functional.silu(x)
def _sigmoid(x):
    return torch.sigmoid(x)
def _layernorm(x, axis=-1, eps=1e-5):
    m = x.mean(dim=axis, keepdim=True)
    v = x.var(dim=axis, keepdim=True, unbiased=False)
    return (x - m) / torch.sqrt(v + eps)
def _scatter_add(tgt, idx, src, axis=0):
    return tgt.clone().index_add_(axis, idx, src)
def _segment_sum(src, seg, n):
    out = torch.zeros((n,) + src.shape[1:], dtype=src.dtype)
    return out.index_add_(0, seg, src)
def _pad(x, pw):
    flat = tuple(v for pair in reversed(pw) for v in pair)
    return torch.nn.functional.pad(x, flat)

kernel_name = 'gated_mix__mha_block_cached__glu_gated_bilinear__decode'

def setup_inputs():

    _w = (lambda a: (lambda t: t.to(torch.bfloat16) if t.is_floating_point() else t)(torch.as_tensor(a)))
    def _A_setup():
        B, Sq, D = 1, 1, 512
        H, Sk, Dh = 32, 8192, 128
        return {
            "x": _w((lambda *s: torch.randn(*s, dtype=torch.bfloat16) * 0.05)(B, Sq, D)),
            "k_cache": _w((lambda *s: torch.randn(*s, dtype=torch.bfloat16) * 3.2)(B, H, Sk, Dh)),
            "v_cache": _w((lambda *s: torch.randn(*s, dtype=torch.bfloat16) * 0.2)(B, H, Sk, Dh)),
            "wq": _w((lambda *s: torch.randn(*s, dtype=torch.bfloat16) * 3.2)(D, H * Dh) * (D ** -0.5)),
            "wo": _w((lambda *s: torch.randn(*s, dtype=torch.bfloat16) * 0.2)(H * Dh, D) * ((H * Dh) ** -0.5)),
        }
    _A_in = _A_setup()

    def _B_setup():
        B, S, D, F = 1, 1, 512, 1376
        return {
            "x": _w((lambda *s: torch.randn(*s, dtype=torch.bfloat16) * 0.05)(B, S, D)),
            "w_gate": _w((lambda *s: torch.randn(*s, dtype=torch.bfloat16) * 0.8)(D, F) * (D ** -0.5)),
            "w_up": _w((lambda *s: torch.randn(*s, dtype=torch.bfloat16) * 0.8)(D, F) * (D ** -0.5)),
            "w_down": _w((lambda *s: torch.randn(*s, dtype=torch.bfloat16) * 0.8)(F, D) * (F ** -0.5)),
        }
    _B_in = _B_setup()

    return {
        "A_x": _A_in["x"],
        "A_k_cache": _A_in["k_cache"],
        "A_v_cache": _A_in["v_cache"],
        "A_wq": _A_in["wq"],
        "A_wo": _A_in["wo"],
        "B_x": _B_in["x"],
        "B_w_gate": _B_in["w_gate"],
        "B_w_up": _B_in["w_up"],
        "B_w_down": _B_in["w_down"],
        "gate_w": _w((lambda *s: torch.randn(*s, dtype=torch.bfloat16) * 0.1)(512) * 16.0),
    }

def reference(A_x, A_k_cache, A_v_cache, A_wq, A_wo, B_x, B_w_gate, B_w_up, B_w_down, gate_w):
    def _A_ref(x, k_cache, v_cache, wq, wo):
        B, Sq, D = x.shape
        H, Dh = 32, 128
        q = (lambda x, *d: x.permute(*d))((x @ wq).reshape(B, Sq, H, Dh), 0, 2, 1, 3)
        scores = torch.einsum("bhqd,bhkd->bhqk", q, k_cache) * (Dh ** -0.5)
        p = _softmax(scores, axis=-1)
        o = torch.einsum("bhqk,bhkd->bhqd", p, v_cache)
        return (lambda x, *d: x.permute(*d))(o, 0, 2, 1, 3).reshape(B, Sq, H * Dh) @ wo

    def _B_ref(x, w_gate, w_up, w_down):
        g = torch.einsum("bsd,df->bsf", x, w_gate)
        u = torch.einsum("bsd,df->bsf", x, w_up)
        h = g * u
        return torch.einsum("bsf,fd->bsd", h, w_down)

    x = A_x
    g = _sigmoid((x * gate_w).sum(-1, keepdims=True))
    a = _A_ref(x, A_k_cache, A_v_cache, A_wq, A_wo)
    b = _B_ref(x, B_w_gate, B_w_up, B_w_down)
    return g * a + (1 - g) * b
```

```asm
; @launch grid=(256,1,1) block=(1024,1,1) lds=8448
.amdgcn_target "amdgcn-amd-amdhsa--gfx950"
.text
.globl gated_mix__mha_block_cached__glu_gated_bilinear__decode_kernel
.p2align 8
.type gated_mix__mha_block_cached__glu_gated_bilinear__decode_kernel,@function
gated_mix__mha_block_cached__glu_gated_bilinear__decode_kernel:
    s_load_dwordx16 s[8:23], s[0:1], 0
    s_load_dwordx8 s[24:31], s[0:1], 64
    s_load_dwordx2 s[32:33], s[0:1], 96
    s_cmp_ge_u32 s2, 256
    s_cbranch_scc1 L_end
    v_and_b32 v125, 63, v0
    v_lshrrev_b32 v126, 6, v0
    v_mov_b32 v127, 0
    v_readfirstlane_b32 s34, v126
    v_lshlrev_b32 v124, 4, v0
    s_and_b32 s35, s2, 7
    s_lshl_b32 s35, s35, 2
    s_lshr_b32 s36, s2, 3
    s_and_b32 s36, s36, 3
    s_or_b32 s35, s35, s36
    s_lshr_b32 s36, s2, 5
    s_lshl_b32 s37, s35, 3
    s_or_b32 s37, s37, s36
    s_cmp_lg_u32 s34, 8
    s_cbranch_scc1 L_noinit
    v_lshlrev_b32 v126, 2, v125
    ds_write_b32 v126, v127
    s_waitcnt lgkmcnt(0)
    s_nop 3
L_noinit:
    s_barrier
    s_lshl_b32 s38, s37, 18
    s_mov_b32 s42, 0x40000
    s_mov_b32 s43, 0x20000
    s_mov_b32 s46, 0x40000
    s_mov_b32 s47, 0x20000
    s_cmp_ge_u32 s34, 8
    s_waitcnt lgkmcnt(0)
    s_cbranch_scc1 L_svc
    s_add_u32 s40, s10, s38
    s_addc_u32 s41, s11, 0
    s_add_u32 s44, s12, s38
    s_addc_u32 s45, s13, 0
    buffer_load_dwordx4 v[0:3], v124, s[40:43], 0 offen nt
    s_mov_b32 s67, 8192
    buffer_load_dwordx4 v[4:7], v124, s[40:43], s67 offen nt
    s_mov_b32 s67, 16384
    buffer_load_dwordx4 v[8:11], v124, s[40:43], s67 offen nt
    s_mov_b32 s60, s32
    s_mov_b32 s61, s33
    s_mov_b32 s62, 3145728
    s_mov_b32 s63, 0x20000
    s_mov_b32 s68, 0xcccccccc
    s_mov_b32 s69, 0xcccccccc
    s_mov_b32 s70, 0xaaaaaaaa
    s_mov_b32 s71, 0xaaaaaaaa
    s_mov_b32 s78, 0x3e0293ee
    s_load_dword s6, s[32:33], 520192
    v_and_b32 v121, 15, v125
    v_lshlrev_b32 v121, 4, v121
    v_mov_b32 v96, 0
    v_mov_b32 v97, 0
    v_mov_b32 v98, 0
    v_mov_b32 v99, 0
    v_mov_b32 v100, 0
    v_mov_b32 v101, 0
    v_mov_b32 v102, 0
    v_mov_b32 v103, 0
    v_mov_b32 v104, 0
    v_mov_b32 v105, 0
    v_mov_b32 v106, 0
    v_mov_b32 v107, 0
    v_mov_b32 v108, 0
    v_mov_b32 v109, 0
    v_mov_b32 v110, 0
    v_mov_b32 v111, 0
    s_waitcnt vmcnt(2)
    s_mov_b32 s67, 24576
    buffer_load_dwordx4 v[12:15], v124, s[40:43], s67 offen nt
    s_waitcnt vmcnt(2)
    s_mov_b32 s67, 32768
    buffer_load_dwordx4 v[16:19], v124, s[40:43], s67 offen nt
    s_waitcnt vmcnt(2)
    s_mov_b32 s67, 40960
    buffer_load_dwordx4 v[20:23], v124, s[40:43], s67 offen nt
    s_waitcnt vmcnt(2)
    s_mov_b32 s67, 49152
    buffer_load_dwordx4 v[24:27], v124, s[40:43], s67 offen nt
    s_waitcnt vmcnt(2)
    s_mov_b32 s67, 57344
    buffer_load_dwordx4 v[28:31], v124, s[40:43], s67 offen nt
    s_waitcnt vmcnt(2)
    s_mov_b32 s67, 65536
    buffer_load_dwordx4 v[32:35], v124, s[40:43], s67 offen nt
    s_waitcnt vmcnt(2)
    s_mov_b32 s67, 73728
    buffer_load_dwordx4 v[36:39], v124, s[40:43], s67 offen nt
    s_waitcnt vmcnt(2)
    s_mov_b32 s67, 81920
    buffer_load_dwordx4 v[40:43], v124, s[40:43], s67 offen nt
    s_waitcnt vmcnt(2)
    s_mov_b32 s67, 90112
    buffer_load_dwordx4 v[44:47], v124, s[40:43], s67 offen nt
    s_waitcnt vmcnt(2)
    s_mov_b32 s67, 98304
    buffer_load_dwordx4 v[48:51], v124, s[40:43], s67 offen nt
    s_waitcnt vmcnt(2)
    s_mov_b32 s67, 106496
    buffer_load_dwordx4 v[52:55], v124, s[40:43], s67 offen nt
    s_waitcnt vmcnt(2)
    s_mov_b32 s67, 114688
    buffer_load_dwordx4 v[56:59], v124, s[40:43], s67 offen nt
    s_waitcnt vmcnt(2)
    s_mov_b32 s67, 122880
    buffer_load_dwordx4 v[60:63], v124, s[40:43], s67 offen nt
    s_waitcnt vmcnt(2)
    buffer_load_dwordx4 v[64:67], v124, s[44:47], 0 offen nt
    s_waitcnt vmcnt(2)
    s_mov_b32 s67, 8192
    buffer_load_dwordx4 v[68:71], v124, s[44:47], s67 offen nt
    s_waitcnt vmcnt(2)
    s_mov_b32 s67, 16384
    buffer_load_dwordx4 v[72:75], v124, s[44:47], s67 offen nt
    s_waitcnt vmcnt(2)
    s_mov_b32 s67, 24576
    buffer_load_dwordx4 v[76:79], v124, s[44:47], s67 offen nt
    s_waitcnt vmcnt(2)
    s_mov_b32 s67, 32768
    buffer_load_dwordx4 v[80:83], v124, s[44:47], s67 offen nt
    s_waitcnt vmcnt(2)
    s_mov_b32 s67, 40960
    buffer_load_dwordx4 v[84:87], v124, s[44:47], s67 offen nt
    s_waitcnt vmcnt(2)
    s_mov_b32 s67, 49152
    buffer_load_dwordx4 v[88:91], v124, s[44:47], s67 offen nt
    s_waitcnt vmcnt(2)
    s_mov_b32 s67, 57344
    buffer_load_dwordx4 v[92:95], v124, s[44:47], s67 offen nt
    s_mov_b32 s75, 1048576
L_lw1:
    ds_read_b32 v126, v127 offset:8
    s_waitcnt lgkmcnt(0)
    v_readfirstlane_b32 s38, v126
    s_nop 1
    s_cmp_lg_u32 s38, 0
    s_nop 3
    s_cbranch_scc1 L_lwd2
    s_sub_u32 s75, s75, 1
    s_cmp_eq_u32 s75, 0
    s_cbranch_scc1 L_end
    s_sleep 2
    s_branch L_lw1
L_lwd2:
    ds_read_b128 v[112:115], v121 offset:256
    s_waitcnt lgkmcnt(0)
    v_dot2c_f32_bf16 v96, v0, v112
    v_dot2c_f32_bf16 v96, v1, v113
    v_dot2c_f32_bf16 v96, v2, v114
    v_dot2c_f32_bf16 v96, v3, v115
    v_dot2c_f32_bf16 v97, v4, v112
    v_dot2c_f32_bf16 v97, v5, v113
    v_dot2c_f32_bf16 v97, v6, v114
    v_dot2c_f32_bf16 v97, v7, v115
    v_dot2c_f32_bf16 v98, v8, v112
    v_dot2c_f32_bf16 v98, v9, v113
    v_dot2c_f32_bf16 v98, v10, v114
    v_dot2c_f32_bf16 v98, v11, v115
    v_dot2c_f32_bf16 v99, v12, v112
    v_dot2c_f32_bf16 v99, v13, v113
    v_dot2c_f32_bf16 v99, v14, v114
    v_dot2c_f32_bf16 v99, v15, v115
    s_waitcnt vmcnt(2)
    s_mov_b32 s67, 65536
    buffer_load_dwordx4 v[0:3], v124, s[44:47], s67 offen nt
    v_dot2c_f32_bf16 v100, v16, v112
    v_dot2c_f32_bf16 v100, v17, v113
    v_dot2c_f32_bf16 v100, v18, v114
    v_dot2c_f32_bf16 v100, v19, v115
    v_dot2c_f32_bf16 v101, v20, v112
    v_dot2c_f32_bf16 v101, v21, v113
    v_dot2c_f32_bf16 v101, v22, v114
    v_dot2c_f32_bf16 v101, v23, v115
    v_dot2c_f32_bf16 v102, v24, v112
    v_dot2c_f32_bf16 v102, v25, v113
    v_dot2c_f32_bf16 v102, v26, v114
    v_dot2c_f32_bf16 v102, v27, v115
    v_dot2c_f32_bf16 v103, v28, v112
    v_dot2c_f32_bf16 v103, v29, v113
    v_dot2c_f32_bf16 v103, v30, v114
    v_dot2c_f32_bf16 v103, v31, v115
    s_waitcnt vmcnt(2)
    s_mov_b32 s67, 73728
    buffer_load_dwordx4 v[4:7], v124, s[44:47], s67 offen nt
    v_dot2c_f32_bf16 v104, v32, v112
    v_dot2c_f32_bf16 v104, v33, v113
    v_dot2c_f32_bf16 v104, v34, v114
    v_dot2c_f32_bf16 v104, v35, v115
    v_dot2c_f32_bf16 v105, v36, v112
    v_dot2c_f32_bf16 v105, v37, v113
    v_dot2c_f32_bf16 v105, v38, v114
    v_dot2c_f32_bf16 v105, v39, v115
    v_dot2c_f32_bf16 v106, v40, v112
    v_dot2c_f32_bf16 v106, v41, v113
    v_dot2c_f32_bf16 v106, v42, v114
    v_dot2c_f32_bf16 v106, v43, v115
    v_dot2c_f32_bf16 v107, v44, v112
    v_dot2c_f32_bf16 v107, v45, v113
    v_dot2c_f32_bf16 v107, v46, v114
    v_dot2c_f32_bf16 v107, v47, v115
    s_waitcnt vmcnt(2)
    s_mov_b32 s67, 81920
    buffer_load_dwordx4 v[8:11], v124, s[44:47], s67 offen nt
    v_dot2c_f32_bf16 v108, v48, v112
    v_dot2c_f32_bf16 v108, v49, v113
    v_dot2c_f32_bf16 v108, v50, v114
    v_dot2c_f32_bf16 v108, v51, v115
    v_dot2c_f32_bf16 v109, v52, v112
    v_dot2c_f32_bf16 v109, v53, v113
    v_dot2c_f32_bf16 v109, v54, v114
    v_dot2c_f32_bf16 v109, v55, v115
    v_dot2c_f32_bf16 v110, v56, v112
    v_dot2c_f32_bf16 v110, v57, v113
    v_dot2c_f32_bf16 v110, v58, v114
    v_dot2c_f32_bf16 v110, v59, v115
    v_dot2c_f32_bf16 v111, v60, v112
    v_dot2c_f32_bf16 v111, v61, v113
    v_dot2c_f32_bf16 v111, v62, v114
    v_dot2c_f32_bf16 v111, v63, v115
    s_waitcnt vmcnt(2)
    s_mov_b32 s67, 90112
    buffer_load_dwordx4 v[12:15], v124, s[44:47], s67 offen nt
    v_add_f32_dpp v96, v96, v96 row_ror:8 row_mask:0xf bank_mask:0x3
    s_nop 1
    v_add_f32_dpp v96, v104, v104 row_ror:8 row_mask:0xf bank_mask:0xc
    v_add_f32_dpp v97, v97, v97 row_ror:8 row_mask:0xf bank_mask:0x3
    s_nop 1
    v_add_f32_dpp v97, v105, v105 row_ror:8 row_mask:0xf bank_mask:0xc
    v_add_f32_dpp v98, v98, v98 row_ror:8 row_mask:0xf bank_mask:0x3
    s_nop 1
    v_add_f32_dpp v98, v106, v106 row_ror:8 row_mask:0xf bank_mask:0xc
    v_add_f32_dpp v99, v99, v99 row_ror:8 row_mask:0xf bank_mask:0x3
    s_nop 1
    v_add_f32_dpp v99, v107, v107 row_ror:8 row_mask:0xf bank_mask:0xc
    v_add_f32_dpp v100, v100, v100 row_ror:8 row_mask:0xf bank_mask:0x3
    s_nop 1
    v_add_f32_dpp v100, v108, v108 row_ror:8 row_mask:0xf bank_mask:0xc
    v_add_f32_dpp v101, v101, v101 row_ror:8 row_mask:0xf bank_mask:0x3
    s_nop 1
    v_add_f32_dpp v101, v109, v109 row_ror:8 row_mask:0xf bank_mask:0xc
    v_add_f32_dpp v102, v102, v102 row_ror:8 row_mask:0xf bank_mask:0x3
    s_nop 1
    v_add_f32_dpp v102, v110, v110 row_ror:8 row_mask:0xf bank_mask:0xc
    v_add_f32_dpp v103, v103, v103 row_ror:8 row_mask:0xf bank_mask:0x3
    s_nop 1
    v_add_f32_dpp v103, v111, v111 row_ror:8 row_mask:0xf bank_mask:0xc
    v_add_f32_dpp v96, v96, v96 row_ror:12 row_mask:0xf bank_mask:0x5
    s_nop 1
    v_add_f32_dpp v96, v100, v100 row_ror:4 row_mask:0xf bank_mask:0xa
    v_add_f32_dpp v97, v97, v97 row_ror:12 row_mask:0xf bank_mask:0x5
    s_nop 1
    v_add_f32_dpp v97, v101, v101 row_ror:4 row_mask:0xf bank_mask:0xa
    v_add_f32_dpp v98, v98, v98 row_ror:12 row_mask:0xf bank_mask:0x5
    s_nop 1
    v_add_f32_dpp v98, v102, v102 row_ror:4 row_mask:0xf bank_mask:0xa
    v_add_f32_dpp v99, v99, v99 row_ror:12 row_mask:0xf bank_mask:0x5
    s_nop 1
    v_add_f32_dpp v99, v103, v103 row_ror:4 row_mask:0xf bank_mask:0xa
    v_add_f32_dpp v96, v96, v96 quad_perm:[2,3,0,1] row_mask:0xf bank_mask:0xf
    v_add_f32_dpp v97, v97, v97 quad_perm:[2,3,0,1] row_mask:0xf bank_mask:0xf
    v_add_f32_dpp v98, v98, v98 quad_perm:[2,3,0,1] row_mask:0xf bank_mask:0xf
    v_add_f32_dpp v99, v99, v99 quad_perm:[2,3,0,1] row_mask:0xf bank_mask:0xf
    v_cndmask_b32 v96, v96, v98, s[68:69]
    v_cndmask_b32 v97, v97, v99, s[68:69]
    s_nop 0
    v_add_f32_dpp v96, v96, v96 quad_perm:[1,0,3,2] row_mask:0xf bank_mask:0xf
    v_add_f32_dpp v97, v97, v97 quad_perm:[1,0,3,2] row_mask:0xf bank_mask:0xf
    v_cndmask_b32 v96, v96, v97, s[70:71]
    v_mul_f32 v96, s78, v96
    v_mov_b32 v97, v96
    s_nop 1
    v_max_f32_dpp v97, v97, v97 row_ror:8 row_mask:0xf bank_mask:0xf
    s_nop 1
    v_max_f32_dpp v97, v97, v97 row_ror:4 row_mask:0xf bank_mask:0xf
    s_nop 1
    v_max_f32_dpp v97, v97, v97 row_ror:2 row_mask:0xf bank_mask:0xf
    s_nop 1
    v_max_f32_dpp v97, v97, v97 row_ror:1 row_mask:0xf bank_mask:0xf
    s_nop 1
    v_max_f32_dpp v97, v97, v97 row_bcast:15 row_mask:0xa bank_mask:0xf
    s_nop 1
    v_max_f32_dpp v97, v97, v97 row_bcast:31 row_mask:0xc bank_mask:0xf
    s_nop 0
    v_readlane_b32 s72, v97, 63
    s_nop 1
    v_subrev_f32 v96, s72, v96
    v_exp_f32 v96, v96
    s_nop 0
    v_cvt_pk_bf16_f32 v110, v96, 0
    v_cvt_pk_bf16_f32 v111, 0, v96
    v_mov_b32 v97, v111
    s_nop 1
    v_add_f32_dpp v97, v97, v97 row_ror:8 row_mask:0xf bank_mask:0xf
    s_nop 1
    v_add_f32_dpp v97, v97, v97 row_ror:4 row_mask:0xf bank_mask:0xf
    s_nop 1
    v_add_f32_dpp v97, v97, v97 row_ror:2 row_mask:0xf bank_mask:0xf
    s_nop 1
    v_add_f32_dpp v97, v97, v97 row_ror:1 row_mask:0xf bank_mask:0xf
    s_nop 1
    v_add_f32_dpp v97, v97, v97 row_bcast:15 row_mask:0xa bank_mask:0xf
    s_nop 1
    v_add_f32_dpp v97, v97, v97 row_bcast:31 row_mask:0xc bank_mask:0xf
    s_nop 0
    v_readlane_b32 s73, v97, 63
    v_mov_b32 v116, 0
    v_mov_b32 v117, 0
    v_mov_b32 v118, 0
    v_mov_b32 v119, 0
    v_mov_b32 v120, 0
    v_mov_b32 v121, 0
    v_mov_b32 v122, 0
    v_mov_b32 v123, 0
    s_add_u32 s4, s6, 1
    s_mul_i32 s5, s4, 0x9e3779b1
    s_xor_b32 s5, s5, 0x5bd1e995
    s_waitcnt vmcnt(2)
    s_mov_b32 s67, 98304
    buffer_load_dwordx4 v[16:19], v124, s[44:47], s67 offen nt
    v_dot2c_f32_bf16_dpp v116, v110, v64 row_newbcast:0 row_mask:0xf bank_mask:0xf
    v_dot2c_f32_bf16_dpp v117, v111, v64 row_newbcast:0 row_mask:0xf bank_mask:0xf
    v_dot2c_f32_bf16_dpp v118, v110, v65 row_newbcast:0 row_mask:0xf bank_mask:0xf
    v_dot2c_f32_bf16_dpp v119, v111, v65 row_newbcast:0 row_mask:0xf bank_mask:0xf
    v_dot2c_f32_bf16_dpp v120, v110, v66 row_newbcast:0 row_mask:0xf bank_mask:0xf
    v_dot2c_f32_bf16_dpp v121, v111, v66 row_newbcast:0 row_mask:0xf bank_mask:0xf
    v_dot2c_f32_bf16_dpp v122, v110, v67 row_newbcast:0 row_mask:0xf bank_mask:0xf
    v_dot2c_f32_bf16_dpp v123, v111, v67 row_newbcast:0 row_mask:0xf bank_mask:0xf
    v_dot2c_f32_bf16_dpp v116, v110, v68 row_newbcast:1 row_mask:0xf bank_mask:0xf
    v_dot2c_f32_bf16_dpp v117, v111, v68 row_newbcast:1 row_mask:0xf bank_mask:0xf
    v_dot2c_f32_bf16_dpp v118, v110, v69 row_newbcast:1 row_mask:0xf bank_mask:0xf
    v_dot2c_f32_bf16_dpp v119, v111, v69 row_newbcast:1 row_mask:0xf bank_mask:0xf
    v_dot2c_f32_bf16_dpp v120, v110, v70 row_newbcast:1 row_mask:0xf bank_mask:0xf
    v_dot2c_f32_bf16_dpp v121, v111, v70 row_newbcast:1 row_mask:0xf bank_mask:0xf
    v_dot2c_f32_bf16_dpp v122, v110, v71 row_newbcast:1 row_mask:0xf bank_mask:0xf
    v_dot2c_f32_bf16_dpp v123, v111, v71 row_newbcast:1 row_mask:0xf bank_mask:0xf
    s_waitcnt vmcnt(2)
    s_mov_b32 s67, 106496
    buffer_load_dwordx4 v[20:23], v124, s[44:47], s67 offen nt
    v_dot2c_f32_bf16_dpp v116, v110, v72 row_newbcast:2 row_mask:0xf bank_mask:0xf
    v_dot2c_f32_bf16_dpp v117, v111, v72 row_newbcast:2 row_mask:0xf bank_mask:0xf
    v_dot2c_f32_bf16_dpp v118, v110, v73 row_newbcast:2 row_mask:0xf bank_mask:0xf
    v_dot2c_f32_bf16_dpp v119, v111, v73 row_newbcast:2 row_mask:0xf bank_mask:0xf
    v_dot2c_f32_bf16_dpp v120, v110, v74 row_newbcast:2 row_mask:0xf bank_mask:0xf
    v_dot2c_f32_bf16_dpp v121, v111, v74 row_newbcast:2 row_mask:0xf bank_mask:0xf
    v_dot2c_f32_bf16_dpp v122, v110, v75 row_newbcast:2 row_mask:0xf bank_mask:0xf
    v_dot2c_f32_bf16_dpp v123, v111, v75 row_newbcast:2 row_mask:0xf bank_mask:0xf
    v_dot2c_f32_bf16_dpp v116, v110, v76 row_newbcast:3 row_mask:0xf bank_mask:0xf
    v_dot2c_f32_bf16_dpp v117, v111, v76 row_newbcast:3 row_mask:0xf bank_mask:0xf
    v_dot2c_f32_bf16_dpp v118, v110, v77 row_newbcast:3 row_mask:0xf bank_mask:0xf
    v_dot2c_f32_bf16_dpp v119, v111, v77 row_newbcast:3 row_mask:0xf bank_mask:0xf
    v_dot2c_f32_bf16_dpp v120, v110, v78 row_newbcast:3 row_mask:0xf bank_mask:0xf
    v_dot2c_f32_bf16_dpp v121, v111, v78 row_newbcast:3 row_mask:0xf bank_mask:0xf
    v_dot2c_f32_bf16_dpp v122, v110, v79 row_newbcast:3 row_mask:0xf bank_mask:0xf
    v_dot2c_f32_bf16_dpp v123, v111, v79 row_newbcast:3 row_mask:0xf bank_mask:0xf
    s_waitcnt vmcnt(2)
    s_mov_b32 s67, 114688
    buffer_load_dwordx4 v[24:27], v124, s[44:47], s67 offen nt
    v_dot2c_f32_bf16_dpp v116, v110, v80 row_newbcast:4 row_mask:0xf bank_mask:0xf
    v_dot2c_f32_bf16_dpp v117, v111, v80 row_newbcast:4 row_mask:0xf bank_mask:0xf
    v_dot2c_f32_bf16_dpp v118, v110, v81 row_newbcast:4 row_mask:0xf bank_mask:0xf
    v_dot2c_f32_bf16_dpp v119, v111, v81 row_newbcast:4 row_mask:0xf bank_mask:0xf
    v_dot2c_f32_bf16_dpp v120, v110, v82 row_newbcast:4 row_mask:0xf bank_mask:0xf
    v_dot2c_f32_bf16_dpp v121, v111, v82 row_newbcast:4 row_mask:0xf bank_mask:0xf
    v_dot2c_f32_bf16_dpp v122, v110, v83 row_newbcast:4 row_mask:0xf bank_mask:0xf
    v_dot2c_f32_bf16_dpp v123, v111, v83 row_newbcast:4 row_mask:0xf bank_mask:0xf
    v_dot2c_f32_bf16_dpp v116, v110, v84 row_newbcast:5 row_mask:0xf bank_mask:0xf
    v_dot2c_f32_bf16_dpp v117, v111, v84 row_newbcast:5 row_mask:0xf bank_mask:0xf
    v_dot2c_f32_bf16_dpp v118, v110, v85 row_newbcast:5 row_mask:0xf bank_mask:0xf
    v_dot2c_f32_bf16_dpp v119, v111, v85 row_newbcast:5 row_mask:0xf bank_mask:0xf
    v_dot2c_f32_bf16_dpp v120, v110, v86 row_newbcast:5 row_mask:0xf bank_mask:0xf
    v_dot2c_f32_bf16_dpp v121, v111, v86 row_newbcast:5 row_mask:0xf bank_mask:0xf
    v_dot2c_f32_bf16_dpp v122, v110, v87 row_newbcast:5 row_mask:0xf bank_mask:0xf
    v_dot2c_f32_bf16_dpp v123, v111, v87 row_newbcast:5 row_mask:0xf bank_mask:0xf
    s_waitcnt vmcnt(2)
    s_mov_b32 s67, 122880
    buffer_load_dwordx4 v[28:31], v124, s[44:47], s67 offen nt
    v_dot2c_f32_bf16_dpp v116, v110, v88 row_newbcast:6 row_mask:0xf bank_mask:0xf
    v_dot2c_f32_bf16_dpp v117, v111, v88 row_newbcast:6 row_mask:0xf bank_mask:0xf
    v_dot2c_f32_bf16_dpp v118, v110, v89 row_newbcast:6 row_mask:0xf bank_mask:0xf
    v_dot2c_f32_bf16_dpp v119, v111, v89 row_newbcast:6 row_mask:0xf bank_mask:0xf
    v_dot2c_f32_bf16_dpp v120, v110, v90 row_newbcast:6 row_mask:0xf bank_mask:0xf
    v_dot2c_f32_bf16_dpp v121, v111, v90 row_newbcast:6 row_mask:0xf bank_mask:0xf
    v_dot2c_f32_bf16_dpp v122, v110, v91 row_newbcast:6 row_mask:0xf bank_mask:0xf
    v_dot2c_f32_bf16_dpp v123, v111, v91 row_newbcast:6 row_mask:0xf bank_mask:0xf
    v_dot2c_f32_bf16_dpp v116, v110, v92 row_newbcast:7 row_mask:0xf bank_mask:0xf
    v_dot2c_f32_bf16_dpp v117, v111, v92 row_newbcast:7 row_mask:0xf bank_mask:0xf
    v_dot2c_f32_bf16_dpp v118, v110, v93 row_newbcast:7 row_mask:0xf bank_mask:0xf
    v_dot2c_f32_bf16_dpp v119, v111, v93 row_newbcast:7 row_mask:0xf bank_mask:0xf
    v_dot2c_f32_bf16_dpp v120, v110, v94 row_newbcast:7 row_mask:0xf bank_mask:0xf
    v_dot2c_f32_bf16_dpp v121, v111, v94 row_newbcast:7 row_mask:0xf bank_mask:0xf
    v_dot2c_f32_bf16_dpp v122, v110, v95 row_newbcast:7 row_mask:0xf bank_mask:0xf
    v_dot2c_f32_bf16_dpp v123, v111, v95 row_newbcast:7 row_mask:0xf bank_mask:0xf
    s_waitcnt vmcnt(2)
    s_mov_b32 s67, 131072
    buffer_load_dwordx4 v[32:35], v124, s[40:43], s67 offen nt
    v_dot2c_f32_bf16_dpp v116, v110, v0 row_newbcast:8 row_mask:0xf bank_mask:0xf
    v_dot2c_f32_bf16_dpp v117, v111, v0 row_newbcast:8 row_mask:0xf bank_mask:0xf
    v_dot2c_f32_bf16_dpp v118, v110, v1 row_newbcast:8 row_mask:0xf bank_mask:0xf
    v_dot2c_f32_bf16_dpp v119, v111, v1 row_newbcast:8 row_mask:0xf bank_mask:0xf
    v_dot2c_f32_bf16_dpp v120, v110, v2 row_newbcast:8 row_mask:0xf bank_mask:0xf
    v_dot2c_f32_bf16_dpp v121, v111, v2 row_newbcast:8 row_mask:0xf bank_mask:0xf
    v_dot2c_f32_bf16_dpp v122, v110, v3 row_newbcast:8 row_mask:0xf bank_mask:0xf
    v_dot2c_f32_bf16_dpp v123, v111, v3 row_newbcast:8 row_mask:0xf bank_mask:0xf
    v_dot2c_f32_bf16_dpp v116, v110, v4 row_newbcast:9 row_mask:0xf bank_mask:0xf
    v_dot2c_f32_bf16_dpp v117, v111, v4 row_newbcast:9 row_mask:0xf bank_mask:0xf
    v_dot2c_f32_bf16_dpp v118, v110, v5 row_newbcast:9 row_mask:0xf bank_mask:0xf
    v_dot2c_f32_bf16_dpp v119, v111, v5 row_newbcast:9 row_mask:0xf bank_mask:0xf
    v_dot2c_f32_bf16_dpp v120, v110, v6 row_newbcast:9 row_mask:0xf bank_mask:0xf
    v_dot2c_f32_bf16_dpp v121, v111, v6 row_newbcast:9 row_mask:0xf bank_mask:0xf
    v_dot2c_f32_bf16_dpp v122, v110, v7 row_newbcast:9 row_mask:0xf bank_mask:0xf
    v_dot2c_f32_bf16_dpp v123, v111, v7 row_newbcast:9 row_mask:0xf bank_mask:0xf
    s_waitcnt vmcnt(2)
    s_mov_b32 s67, 139264
    buffer_load_dwordx4 v[36:39], v124, s[40:43], s67 offen nt
    v_dot2c_f32_bf16_dpp v116, v110, v8 row_newbcast:10 row_mask:0xf bank_mask:0xf
    v_dot2c_f32_bf16_dpp v117, v111, v8 row_newbcast:10 row_mask:0xf bank_mask:0xf
    v_dot2c_f32_bf16_dpp v118, v110, v9 row_newbcast:10 row_mask:0xf bank_mask:0xf
    v_dot2c_f32_bf16_dpp v119, v111, v9 row_newbcast:10 row_mask:0xf bank_mask:0xf
    v_dot2c_f32_bf16_dpp v120, v110, v10 row_newbcast:10 row_mask:0xf bank_mask:0xf
    v_dot2c_f32_bf16_dpp v121, v111, v10 row_newbcast:10 row_mask:0xf bank_mask:0xf
    v_dot2c_f32_bf16_dpp v122, v110, v11 row_newbcast:10 row_mask:0xf bank_mask:0xf
    v_dot2c_f32_bf16_dpp v123, v111, v11 row_newbcast:10 row_mask:0xf bank_mask:0xf
    v_dot2c_f32_bf16_dpp v116, v110, v12 row_newbcast:11 row_mask:0xf bank_mask:0xf
    v_dot2c_f32_bf16_dpp v117, v111, v12 row_newbcast:11 row_mask:0xf bank_mask:0xf
    v_dot2c_f32_bf16_dpp v118, v110, v13 row_newbcast:11 row_mask:0xf bank_mask:0xf
    v_dot2c_f32_bf16_dpp v119, v111, v13 row_newbcast:11 row_mask:0xf bank_mask:0xf
    v_dot2c_f32_bf16_dpp v120, v110, v14 row_newbcast:11 row_mask:0xf bank_mask:0xf
    v_dot2c_f32_bf16_dpp v121, v111, v14 row_newbcast:11 row_mask:0xf bank_mask:0xf
    v_dot2c_f32_bf16_dpp v122, v110, v15 row_newbcast:11 row_mask:0xf bank_mask:0xf
    v_dot2c_f32_bf16_dpp v123, v111, v15 row_newbcast:11 row_mask:0xf bank_mask:0xf
    s_waitcnt vmcnt(2)
    s_mov_b32 s67, 147456
    buffer_load_dwordx4 v[40:43], v124, s[40:43], s67 offen nt
    v_dot2c_f32_bf16_dpp v116, v110, v16 row_newbcast:12 row_mask:0xf bank_mask:0xf
    v_dot2c_f32_bf16_dpp v117, v111, v16 row_newbcast:12 row_mask:0xf bank_mask:0xf
    v_dot2c_f32_bf16_dpp v118, v110, v17 row_newbcast:12 row_mask:0xf bank_mask:0xf
    v_dot2c_f32_bf16_dpp v119, v111, v17 row_newbcast:12 row_mask:0xf bank_mask:0xf
    v_dot2c_f32_bf16_dpp v120, v110, v18 row_newbcast:12 row_mask:0xf bank_mask:0xf
    v_dot2c_f32_bf16_dpp v121, v111, v18 row_newbcast:12 row_mask:0xf bank_mask:0xf
    v_dot2c_f32_bf16_dpp v122, v110, v19 row_newbcast:12 row_mask:0xf bank_mask:0xf
    v_dot2c_f32_bf16_dpp v123, v111, v19 row_newbcast:12 row_mask:0xf bank_mask:0xf
    v_dot2c_f32_bf16_dpp v116, v110, v20 row_newbcast:13 row_mask:0xf bank_mask:0xf
    v_dot2c_f32_bf16_dpp v117, v111, v20 row_newbcast:13 row_mask:0xf bank_mask:0xf
    v_dot2c_f32_bf16_dpp v118, v110, v21 row_newbcast:13 row_mask:0xf bank_mask:0xf
    v_dot2c_f32_bf16_dpp v119, v111, v21 row_newbcast:13 row_mask:0xf bank_mask:0xf
    v_dot2c_f32_bf16_dpp v120, v110, v22 row_newbcast:13 row_mask:0xf bank_mask:0xf
    v_dot2c_f32_bf16_dpp v121, v111, v22 row_newbcast:13 row_mask:0xf bank_mask:0xf
    v_dot2c_f32_bf16_dpp v122, v110, v23 row_newbcast:13 row_mask:0xf bank_mask:0xf
    v_dot2c_f32_bf16_dpp v123, v111, v23 row_newbcast:13 row_mask:0xf bank_mask:0xf
    s_waitcnt vmcnt(2)
    s_mov_b32 s67, 155648
    buffer_load_dwordx4 v[44:47], v124, s[40:43], s67 offen nt
    v_dot2c_f32_bf16_dpp v116, v110, v24 row_newbcast:14 row_mask:0xf bank_mask:0xf
    v_dot2c_f32_bf16_dpp v117, v111, v24 row_newbcast:14 row_mask:0xf bank_mask:0xf
    v_dot2c_f32_bf16_dpp v118, v110, v25 row_newbcast:14 row_mask:0xf bank_mask:0xf
    v_dot2c_f32_bf16_dpp v119, v111, v25 row_newbcast:14 row_mask:0xf bank_mask:0xf
    v_dot2c_f32_bf16_dpp v120, v110, v26 row_newbcast:14 row_mask:0xf bank_mask:0xf
    v_dot2c_f32_bf16_dpp v121, v111, v26 row_newbcast:14 row_mask:0xf bank_mask:0xf
    v_dot2c_f32_bf16_dpp v122, v110, v27 row_newbcast:14 row_mask:0xf bank_mask:0xf
    v_dot2c_f32_bf16_dpp v123, v111, v27 row_newbcast:14 row_mask:0xf bank_mask:0xf
    v_dot2c_f32_bf16_dpp v116, v110, v28 row_newbcast:15 row_mask:0xf bank_mask:0xf
    v_dot2c_f32_bf16_dpp v117, v111, v28 row_newbcast:15 row_mask:0xf bank_mask:0xf
    v_dot2c_f32_bf16_dpp v118, v110, v29 row_newbcast:15 row_mask:0xf bank_mask:0xf
    v_dot2c_f32_bf16_dpp v119, v111, v29 row_newbcast:15 row_mask:0xf bank_mask:0xf
    v_dot2c_f32_bf16_dpp v120, v110, v30 row_newbcast:15 row_mask:0xf bank_mask:0xf
    v_dot2c_f32_bf16_dpp v121, v111, v30 row_newbcast:15 row_mask:0xf bank_mask:0xf
    v_dot2c_f32_bf16_dpp v122, v110, v31 row_newbcast:15 row_mask:0xf bank_mask:0xf
    v_dot2c_f32_bf16_dpp v123, v111, v31 row_newbcast:15 row_mask:0xf bank_mask:0xf
    v_mov_b32 v96, 0
    v_mov_b32 v97, 0
    v_mov_b32 v98, 0
    v_mov_b32 v99, 0
    v_mov_b32 v100, 0
    v_mov_b32 v101, 0
    v_mov_b32 v102, 0
    v_mov_b32 v103, 0
    v_mov_b32 v104, 0
    v_mov_b32 v105, 0
    v_mov_b32 v106, 0
    v_mov_b32 v107, 0
    v_mov_b32 v108, 0
    v_mov_b32 v109, 0
    v_mov_b32 v110, 0
    v_mov_b32 v111, 0
    v_dot2c_f32_bf16 v96, v32, v112
    v_dot2c_f32_bf16 v96, v33, v113
    v_dot2c_f32_bf16 v96, v34, v114
    v_dot2c_f32_bf16 v96, v35, v115
    s_waitcnt vmcnt(2)
    s_mov_b32 s67, 163840
    buffer_load_dwordx4 v[48:51], v124, s[40:43], s67 offen nt
    v_dot2c_f32_bf16 v97, v36, v112
    v_dot2c_f32_bf16 v97, v37, v113
    v_dot2c_f32_bf16 v97, v38, v114
    v_dot2c_f32_bf16 v97, v39, v115
    s_waitcnt vmcnt(2)
    s_mov_b32 s67, 172032
    buffer_load_dwordx4 v[52:55], v124, s[40:43], s67 offen nt
    v_dot2c_f32_bf16 v98, v40, v112
    v_dot2c_f32_bf16 v98, v41, v113
    v_dot2c_f32_bf16 v98, v42, v114
    v_dot2c_f32_bf16 v98, v43, v115
    s_waitcnt vmcnt(2)
    s_mov_b32 s67, 180224
    buffer_load_dwordx4 v[56:59], v124, s[40:43], s67 offen nt
    v_dot2c_f32_bf16 v99, v44, v112
    v_dot2c_f32_bf16 v99, v45, v113
    v_dot2c_f32_bf16 v99, v46, v114
    v_dot2c_f32_bf16 v99, v47, v115
    s_waitcnt vmcnt(2)
    s_mov_b32 s67, 188416
    buffer_load_dwordx4 v[60:63], v124, s[40:43], s67 offen nt
    v_dot2c_f32_bf16 v100, v48, v112
    v_dot2c_f32_bf16 v100, v49, v113
    v_dot2c_f32_bf16 v100, v50, v114
    v_dot2c_f32_bf16 v100, v51, v115
    s_waitcnt vmcnt(2)
    s_mov_b32 s67, 196608
    buffer_load_dwordx4 v[64:67], v124, s[40:43], s67 offen nt
    v_dot2c_f32_bf16 v101, v52, v112
    v_dot2c_f32_bf16 v101, v53, v113
    v_dot2c_f32_bf16 v101, v54, v114
    v_dot2c_f32_bf16 v101, v55, v115
    s_waitcnt vmcnt(2)
    s_mov_b32 s67, 204800
    buffer_load_dwordx4 v[68:71], v124, s[40:43], s67 offen nt
    v_dot2c_f32_bf16 v102, v56, v112
    v_dot2c_f32_bf16 v102, v57, v113
    v_dot2c_f32_bf16 v102, v58, v114
    v_dot2c_f32_bf16 v102, v59, v115
    s_waitcnt vmcnt(2)
    s_mov_b32 s67, 212992
    buffer_load_dwordx4 v[72:75], v124, s[40:43], s67 offen nt
    v_dot2c_f32_bf16 v103, v60, v112
    v_dot2c_f32_bf16 v103, v61, v113
    v_dot2c_f32_bf16 v103, v62, v114
    v_dot2c_f32_bf16 v103, v63, v115
    s_waitcnt vmcnt(2)
    s_mov_b32 s67, 221184
    buffer_load_dwordx4 v[76:79], v124, s[40:43], s67 offen nt
    v_dot2c_f32_bf16 v104, v64, v112
    v_dot2c_f32_bf16 v104, v65, v113
    v_dot2c_f32_bf16 v104, v66, v114
    v_dot2c_f32_bf16 v104, v67, v115
    s_waitcnt vmcnt(2)
    s_mov_b32 s67, 229376
    buffer_load_dwordx4 v[80:83], v124, s[40:43], s67 offen nt
    v_dot2c_f32_bf16 v105, v68, v112
    v_dot2c_f32_bf16 v105, v69, v113
    v_dot2c_f32_bf16 v105, v70, v114
    v_dot2c_f32_bf16 v105, v71, v115
    s_waitcnt vmcnt(2)
    s_mov_b32 s67, 237568
    buffer_load_dwordx4 v[84:87], v124, s[40:43], s67 offen nt
    v_dot2c_f32_bf16 v106, v72, v112
    v_dot2c_f32_bf16 v106, v73, v113
    v_dot2c_f32_bf16 v106, v74, v114
    v_dot2c_f32_bf16 v106, v75, v115
    s_waitcnt vmcnt(2)
    s_mov_b32 s67, 245760
    buffer_load_dwordx4 v[88:91], v124, s[40:43], s67 offen nt
    v_dot2c_f32_bf16 v107, v76, v112
    v_dot2c_f32_bf16 v107, v77, v113
    v_dot2c_f32_bf16 v107, v78, v114
    v_dot2c_f32_bf16 v107, v79, v115
    s_waitcnt vmcnt(2)
    s_mov_b32 s67, 253952
    buffer_load_dwordx4 v[92:95], v124, s[40:43], s67 offen nt
    v_dot2c_f32_bf16 v108, v80, v112
    v_dot2c_f32_bf16 v108, v81, v113
    v_dot2c_f32_bf16 v108, v82, v114
    v_dot2c_f32_bf16 v108, v83, v115
    s_mov_b32 s67, 131072
    buffer_load_dwordx4 v[0:3], v124, s[44:47], s67 offen nt
    s_waitcnt vmcnt(3)
    v_dot2c_f32_bf16 v109, v84, v112
    v_dot2c_f32_bf16 v109, v85, v113
    v_dot2c_f32_bf16 v109, v86, v114
    v_dot2c_f32_bf16 v109, v87, v115
    s_mov_b32 s67, 139264
    buffer_load_dwordx4 v[4:7], v124, s[44:47], s67 offen nt
    s_waitcnt vmcnt(3)
    v_dot2c_f32_bf16 v110, v88, v112
    v_dot2c_f32_bf16 v110, v89, v113
    v_dot2c_f32_bf16 v110, v90, v114
    v_dot2c_f32_bf16 v110, v91, v115
    s_mov_b32 s67, 147456
    buffer_load_dwordx4 v[8:11], v124, s[44:47], s67 offen nt
    s_waitcnt vmcnt(3)
    v_dot2c_f32_bf16 v111, v92, v112
    v_dot2c_f32_bf16 v111, v93, v113
    v_dot2c_f32_bf16 v111, v94, v114
    v_dot2c_f32_bf16 v111, v95, v115
    v_add_f32_dpp v96, v96, v96 row_ror:8 row_mask:0xf bank_mask:0x3
    s_nop 1
    v_add_f32_dpp v96, v104, v104 row_ror:8 row_mask:0xf bank_mask:0xc
    v_add_f32_dpp v97, v97, v97 row_ror:8 row_mask:0xf bank_mask:0x3
    s_nop 1
    v_add_f32_dpp v97, v105, v105 row_ror:8 row_mask:0xf bank_mask:0xc
    v_add_f32_dpp v98, v98, v98 row_ror:8 row_mask:0xf bank_mask:0x3
    s_nop 1
    v_add_f32_dpp v98, v106, v106 row_ror:8 row_mask:0xf bank_mask:0xc
    v_add_f32_dpp v99, v99, v99 row_ror:8 row_mask:0xf bank_mask:0x3
    s_nop 1
    v_add_f32_dpp v99, v107, v107 row_ror:8 row_mask:0xf bank_mask:0xc
    v_add_f32_dpp v100, v100, v100 row_ror:8 row_mask:0xf bank_mask:0x3
    s_nop 1
    v_add_f32_dpp v100, v108, v108 row_ror:8 row_mask:0xf bank_mask:0xc
    v_add_f32_dpp v101, v101, v101 row_ror:8 row_mask:0xf bank_mask:0x3
    s_nop 1
    v_add_f32_dpp v101, v109, v109 row_ror:8 row_mask:0xf bank_mask:0xc
    v_add_f32_dpp v102, v102, v102 row_ror:8 row_mask:0xf bank_mask:0x3
    s_nop 1
    v_add_f32_dpp v102, v110, v110 row_ror:8 row_mask:0xf bank_mask:0xc
    v_add_f32_dpp v103, v103, v103 row_ror:8 row_mask:0xf bank_mask:0x3
    s_nop 1
    v_add_f32_dpp v103, v111, v111 row_ror:8 row_mask:0xf bank_mask:0xc
    v_add_f32_dpp v96, v96, v96 row_ror:12 row_mask:0xf bank_mask:0x5
    s_nop 1
    v_add_f32_dpp v96, v100, v100 row_ror:4 row_mask:0xf bank_mask:0xa
    v_add_f32_dpp v97, v97, v97 row_ror:12 row_mask:0xf bank_mask:0x5
    s_nop 1
    v_add_f32_dpp v97, v101, v101 row_ror:4 row_mask:0xf bank_mask:0xa
    v_add_f32_dpp v98, v98, v98 row_ror:12 row_mask:0xf bank_mask:0x5
    s_nop 1
    v_add_f32_dpp v98, v102, v102 row_ror:4 row_mask:0xf bank_mask:0xa
    v_add_f32_dpp v99, v99, v99 row_ror:12 row_mask:0xf bank_mask:0x5
    s_nop 1
    v_add_f32_dpp v99, v103, v103 row_ror:4 row_mask:0xf bank_mask:0xa
    v_add_f32_dpp v96, v96, v96 quad_perm:[2,3,0,1] row_mask:0xf bank_mask:0xf
    v_add_f32_dpp v97, v97, v97 quad_perm:[2,3,0,1] row_mask:0xf bank_mask:0xf
    v_add_f32_dpp v98, v98, v98 quad_perm:[2,3,0,1] row_mask:0xf bank_mask:0xf
    v_add_f32_dpp v99, v99, v99 quad_perm:[2,3,0,1] row_mask:0xf bank_mask:0xf
    v_cndmask_b32 v96, v96, v98, s[68:69]
    v_cndmask_b32 v97, v97, v99, s[68:69]
    s_nop 0
    v_add_f32_dpp v96, v96, v96 quad_perm:[1,0,3,2] row_mask:0xf bank_mask:0xf
    v_add_f32_dpp v97, v97, v97 quad_perm:[1,0,3,2] row_mask:0xf bank_mask:0xf
    v_cndmask_b32 v96, v96, v97, s[70:71]
    v_mul_f32 v96, s78, v96
    v_mov_b32 v97, v96
    s_nop 1
    v_max_f32_dpp v97, v97, v97 row_ror:8 row_mask:0xf bank_mask:0xf
    s_nop 1
    v_max_f32_dpp v97, v97, v97 row_ror:4 row_mask:0xf bank_mask:0xf
    s_nop 1
    v_max_f32_dpp v97, v97, v97 row_ror:2 row_mask:0xf bank_mask:0xf
    s_nop 1
    v_max_f32_dpp v97, v97, v97 row_ror:1 row_mask:0xf bank_mask:0xf
    s_nop 1
    v_max_f32_dpp v97, v97, v97 row_bcast:15 row_mask:0xa bank_mask:0xf
    s_nop 1
    v_max_f32_dpp v97, v97, v97 row_bcast:31 row_mask:0xc bank_mask:0xf
    s_nop 0
    v_readlane_b32 s74, v97, 63
    v_mov_b32 v98, s72
    s_nop 0
    v_max_f32 v98, s74, v98
    v_sub_f32 v96, v96, v98
    v_sub_f32 v99, s72, v98
    v_exp_f32 v96, v96
    v_exp_f32 v99, v99
    v_readfirstlane_b32 s72, v98
    v_cvt_pk_bf16_f32 v110, v96, 0
    v_cvt_pk_bf16_f32 v111, 0, v96
    v_mul_f32 v116, v99, v116
    v_mul_f32 v117, v99, v117
    v_mul_f32 v118, v99, v118
    v_mul_f32 v119, v99, v119
    v_mul_f32 v120, v99, v120
    v_mul_f32 v121, v99, v121
    v_mul_f32 v122, v99, v122
    v_mul_f32 v123, v99, v123
    s_mov_b64 exec, 1
    s_lshl_b32 s38, s34, 2
    v_mov_b32 v97, s38
    ds_write_b32 v97, v98 offset:64
    v_mov_b32 v98, 1
    ds_add_u32 v127, v98 offset:12
    s_mov_b64 exec, -1
    v_mov_b32 v97, v111
    s_nop 1
    v_add_f32_dpp v97, v97, v97 row_ror:8 row_mask:0xf bank_mask:0xf
    s_nop 1
    v_add_f32_dpp v97, v97, v97 row_ror:4 row_mask:0xf bank_mask:0xf
    s_nop 1
    v_add_f32_dpp v97, v97, v97 row_ror:2 row_mask:0xf bank_mask:0xf
    s_nop 1
    v_add_f32_dpp v97, v97, v97 row_ror:1 row_mask:0xf bank_mask:0xf
    s_nop 1
    v_add_f32_dpp v97, v97, v97 row_bcast:15 row_mask:0xa bank_mask:0xf
    s_nop 1
    v_add_f32_dpp v97, v97, v97 row_bcast:31 row_mask:0xc bank_mask:0xf
    v_mul_f32 v99, s73, v99
    v_readlane_b32 s73, v97, 63
    s_nop 1
    v_add_f32 v102, s73, v99
    s_mov_b32 s67, 155648
    buffer_load_dwordx4 v[12:15], v124, s[44:47], s67 offen nt
    s_mov_b32 s67, 163840
    buffer_load_dwordx4 v[16:19], v124, s[44:47], s67 offen nt
    s_mov_b32 s67, 172032
    buffer_load_dwordx4 v[20:23], v124, s[44:47], s67 offen nt
    s_mov_b32 s67, 180224
    buffer_load_dwordx4 v[24:27], v124, s[44:47], s67 offen nt
    s_mov_b32 s67, 188416
    buffer_load_dwordx4 v[28:31], v124, s[44:47], s67 offen nt
    s_waitcnt vmcnt(7)
    s_mov_b32 s67, 196608
    buffer_load_dwordx4 v[32:35], v124, s[44:47], s67 offen nt
    v_dot2c_f32_bf16_dpp v116, v110, v0 row_newbcast:0 row_mask:0xf bank_mask:0xf
    v_dot2c_f32_bf16_dpp v117, v111, v0 row_newbcast:0 row_mask:0xf bank_mask:0xf
    v_dot2c_f32_bf16_dpp v118, v110, v1 row_newbcast:0 row_mask:0xf bank_mask:0xf
    v_dot2c_f32_bf16_dpp v119, v111, v1 row_newbcast:0 row_mask:0xf bank_mask:0xf
    v_dot2c_f32_bf16_dpp v120, v110, v2 row_newbcast:0 row_mask:0xf bank_mask:0xf
    v_dot2c_f32_bf16_dpp v121, v111, v2 row_newbcast:0 row_mask:0xf bank_mask:0xf
    v_dot2c_f32_bf16_dpp v122, v110, v3 row_newbcast:0 row_mask:0xf bank_mask:0xf
    v_dot2c_f32_bf16_dpp v123, v111, v3 row_newbcast:0 row_mask:0xf bank_mask:0xf
    s_waitcnt vmcnt(7)
    s_mov_b32 s67, 204800
    buffer_load_dwordx4 v[36:39], v124, s[44:47], s67 offen nt
    v_dot2c_f32_bf16_dpp v116, v110, v4 row_newbcast:1 row_mask:0xf bank_mask:0xf
    v_dot2c_f32_bf16_dpp v117, v111, v4 row_newbcast:1 row_mask:0xf bank_mask:0xf
    v_dot2c_f32_bf16_dpp v118, v110, v5 row_newbcast:1 row_mask:0xf bank_mask:0xf
    v_dot2c_f32_bf16_dpp v119, v111, v5 row_newbcast:1 row_mask:0xf bank_mask:0xf
    v_dot2c_f32_bf16_dpp v120, v110, v6 row_newbcast:1 row_mask:0xf bank_mask:0xf
    v_dot2c_f32_bf16_dpp v121, v111, v6 row_newbcast:1 row_mask:0xf bank_mask:0xf
    v_dot2c_f32_bf16_dpp v122, v110, v7 row_newbcast:1 row_mask:0xf bank_mask:0xf
    v_dot2c_f32_bf16_dpp v123, v111, v7 row_newbcast:1 row_mask:0xf bank_mask:0xf
    s_waitcnt vmcnt(7)
    s_mov_b32 s67, 212992
    buffer_load_dwordx4 v[40:43], v124, s[44:47], s67 offen nt
    v_dot2c_f32_bf16_dpp v116, v110, v8 row_newbcast:2 row_mask:0xf bank_mask:0xf
    v_dot2c_f32_bf16_dpp v117, v111, v8 row_newbcast:2 row_mask:0xf bank_mask:0xf
    v_dot2c_f32_bf16_dpp v118, v110, v9 row_newbcast:2 row_mask:0xf bank_mask:0xf
    v_dot2c_f32_bf16_dpp v119, v111, v9 row_newbcast:2 row_mask:0xf bank_mask:0xf
    v_dot2c_f32_bf16_dpp v120, v110, v10 row_newbcast:2 row_mask:0xf bank_mask:0xf
    v_dot2c_f32_bf16_dpp v121, v111, v10 row_newbcast:2 row_mask:0xf bank_mask:0xf
    v_dot2c_f32_bf16_dpp v122, v110, v11 row_newbcast:2 row_mask:0xf bank_mask:0xf
    v_dot2c_f32_bf16_dpp v123, v111, v11 row_newbcast:2 row_mask:0xf bank_mask:0xf
    s_waitcnt vmcnt(7)
    s_mov_b32 s67, 221184
    buffer_load_dwordx4 v[44:47], v124, s[44:47], s67 offen nt
    v_dot2c_f32_bf16_dpp v116, v110, v12 row_newbcast:3 row_mask:0xf bank_mask:0xf
    v_dot2c_f32_bf16_dpp v117, v111, v12 row_newbcast:3 row_mask:0xf bank_mask:0xf
    v_dot2c_f32_bf16_dpp v118, v110, v13 row_newbcast:3 row_mask:0xf bank_mask:0xf
    v_dot2c_f32_bf16_dpp v119, v111, v13 row_newbcast:3 row_mask:0xf bank_mask:0xf
    v_dot2c_f32_bf16_dpp v120, v110, v14 row_newbcast:3 row_mask:0xf bank_mask:0xf
    v_dot2c_f32_bf16_dpp v121, v111, v14 row_newbcast:3 row_mask:0xf bank_mask:0xf
    v_dot2c_f32_bf16_dpp v122, v110, v15 row_newbcast:3 row_mask:0xf bank_mask:0xf
    v_dot2c_f32_bf16_dpp v123, v111, v15 row_newbcast:3 row_mask:0xf bank_mask:0xf
    s_waitcnt vmcnt(7)
    s_mov_b32 s67, 229376
    buffer_load_dwordx4 v[48:51], v124, s[44:47], s67 offen nt
    v_dot2c_f32_bf16_dpp v116, v110, v16 row_newbcast:4 row_mask:0xf bank_mask:0xf
    v_dot2c_f32_bf16_dpp v117, v111, v16 row_newbcast:4 row_mask:0xf bank_mask:0xf
    v_dot2c_f32_bf16_dpp v118, v110, v17 row_newbcast:4 row_mask:0xf bank_mask:0xf
    v_dot2c_f32_bf16_dpp v119, v111, v17 row_newbcast:4 row_mask:0xf bank_mask:0xf
    v_dot2c_f32_bf16_dpp v120, v110, v18 row_newbcast:4 row_mask:0xf bank_mask:0xf
    v_dot2c_f32_bf16_dpp v121, v111, v18 row_newbcast:4 row_mask:0xf bank_mask:0xf
    v_dot2c_f32_bf16_dpp v122, v110, v19 row_newbcast:4 row_mask:0xf bank_mask:0xf
    v_dot2c_f32_bf16_dpp v123, v111, v19 row_newbcast:4 row_mask:0xf bank_mask:0xf
    s_waitcnt vmcnt(7)
    s_mov_b32 s67, 237568
    buffer_load_dwordx4 v[52:55], v124, s[44:47], s67 offen nt
    v_dot2c_f32_bf16_dpp v116, v110, v20 row_newbcast:5 row_mask:0xf bank_mask:0xf
    v_dot2c_f32_bf16_dpp v117, v111, v20 row_newbcast:5 row_mask:0xf bank_mask:0xf
    v_dot2c_f32_bf16_dpp v118, v110, v21 row_newbcast:5 row_mask:0xf bank_mask:0xf
    v_dot2c_f32_bf16_dpp v119, v111, v21 row_newbcast:5 row_mask:0xf bank_mask:0xf
    v_dot2c_f32_bf16_dpp v120, v110, v22 row_newbcast:5 row_mask:0xf bank_mask:0xf
    v_dot2c_f32_bf16_dpp v121, v111, v22 row_newbcast:5 row_mask:0xf bank_mask:0xf
    v_dot2c_f32_bf16_dpp v122, v110, v23 row_newbcast:5 row_mask:0xf bank_mask:0xf
    v_dot2c_f32_bf16_dpp v123, v111, v23 row_newbcast:5 row_mask:0xf bank_mask:0xf
    s_waitcnt vmcnt(7)
    s_mov_b32 s67, 245760
    buffer_load_dwordx4 v[56:59], v124, s[44:47], s67 offen nt
    v_dot2c_f32_bf16_dpp v116, v110, v24 row_newbcast:6 row_mask:0xf bank_mask:0xf
    v_dot2c_f32_bf16_dpp v117, v111, v24 row_newbcast:6 row_mask:0xf bank_mask:0xf
    v_dot2c_f32_bf16_dpp v118, v110, v25 row_newbcast:6 row_mask:0xf bank_mask:0xf
    v_dot2c_f32_bf16_dpp v119, v111, v25 row_newbcast:6 row_mask:0xf bank_mask:0xf
    v_dot2c_f32_bf16_dpp v120, v110, v26 row_newbcast:6 row_mask:0xf bank_mask:0xf
    v_dot2c_f32_bf16_dpp v121, v111, v26 row_newbcast:6 row_mask:0xf bank_mask:0xf
    v_dot2c_f32_bf16_dpp v122, v110, v27 row_newbcast:6 row_mask:0xf bank_mask:0xf
    v_dot2c_f32_bf16_dpp v123, v111, v27 row_newbcast:6 row_mask:0xf bank_mask:0xf
    s_waitcnt vmcnt(7)
    s_mov_b32 s67, 253952
    buffer_load_dwordx4 v[60:63], v124, s[44:47], s67 offen nt
    v_dot2c_f32_bf16_dpp v116, v110, v28 row_newbcast:7 row_mask:0xf bank_mask:0xf
    v_dot2c_f32_bf16_dpp v117, v111, v28 row_newbcast:7 row_mask:0xf bank_mask:0xf
    v_dot2c_f32_bf16_dpp v118, v110, v29 row_newbcast:7 row_mask:0xf bank_mask:0xf
    v_dot2c_f32_bf16_dpp v119, v111, v29 row_newbcast:7 row_mask:0xf bank_mask:0xf
    v_dot2c_f32_bf16_dpp v120, v110, v30 row_newbcast:7 row_mask:0xf bank_mask:0xf
    v_dot2c_f32_bf16_dpp v121, v111, v30 row_newbcast:7 row_mask:0xf bank_mask:0xf
    v_dot2c_f32_bf16_dpp v122, v110, v31 row_newbcast:7 row_mask:0xf bank_mask:0xf
    v_dot2c_f32_bf16_dpp v123, v111, v31 row_newbcast:7 row_mask:0xf bank_mask:0xf
    s_mov_b32 s75, 1048576
    s_nop 3
L_lw3:
    ds_read_b32 v126, v127 offset:12
    s_waitcnt lgkmcnt(0)
    v_readfirstlane_b32 s38, v126
    s_nop 1
    s_cmp_ge_u32 s38, 8
    s_nop 3
    s_cbranch_scc1 L_lwd4
    s_sub_u32 s75, s75, 1
    s_cmp_eq_u32 s75, 0
    s_cbranch_scc1 L_end
    s_sleep 1
    s_branch L_lw3
L_lwd4:
    v_and_b32 v99, 7, v125
    v_lshlrev_b32 v99, 2, v99
    ds_read_b32 v100, v99 offset:64
    v_lshrrev_b32 v98, 4, v125
    v_and_b32 v103, 15, v125
    v_lshlrev_b32 v103, 5, v103
    v_lshl_add_u32 v103, v98, 3, v103
    s_mul_i32 s38, s34, 544
    v_add_u32 v104, s38, v103
    s_waitcnt lgkmcnt(0)
    v_max_f32_dpp v100, v100, v100 quad_perm:[1,0,3,2] row_mask:0xf bank_mask:0xf
    s_nop 1
    v_max_f32_dpp v100, v100, v100 quad_perm:[2,3,0,1] row_mask:0xf bank_mask:0xf
    s_nop 1
    v_max_f32_dpp v100, v100, v100 row_half_mirror row_mask:0xf bank_mask:0xf
    v_sub_f32 v101, s72, v100
    v_exp_f32 v101, v101
    s_lshl_b32 s38, s34, 2
    v_mov_b32 v99, s38
    v_mul_f32 v102, v102, v101
    s_mov_b64 exec, 1
    ds_write_b32 v99, v102 offset:128
    v_mov_b32 v99, 1
    ds_add_u32 v127, v99 offset:16
    s_mov_b64 exec, -1
    s_waitcnt vmcnt(7)
    v_dot2c_f32_bf16_dpp v116, v110, v32 row_newbcast:8 row_mask:0xf bank_mask:0xf
    v_dot2c_f32_bf16_dpp v117, v111, v32 row_newbcast:8 row_mask:0xf bank_mask:0xf
    v_dot2c_f32_bf16_dpp v118, v110, v33 row_newbcast:8 row_mask:0xf bank_mask:0xf
    v_dot2c_f32_bf16_dpp v119, v111, v33 row_newbcast:8 row_mask:0xf bank_mask:0xf
    v_dot2c_f32_bf16_dpp v120, v110, v34 row_newbcast:8 row_mask:0xf bank_mask:0xf
    v_dot2c_f32_bf16_dpp v121, v111, v34 row_newbcast:8 row_mask:0xf bank_mask:0xf
    v_dot2c_f32_bf16_dpp v122, v110, v35 row_newbcast:8 row_mask:0xf bank_mask:0xf
    v_dot2c_f32_bf16_dpp v123, v111, v35 row_newbcast:8 row_mask:0xf bank_mask:0xf
    s_waitcnt vmcnt(6)
    v_dot2c_f32_bf16_dpp v116, v110, v36 row_newbcast:9 row_mask:0xf bank_mask:0xf
    v_dot2c_f32_bf16_dpp v117, v111, v36 row_newbcast:9 row_mask:0xf bank_mask:0xf
    v_dot2c_f32_bf16_dpp v118, v110, v37 row_newbcast:9 row_mask:0xf bank_mask:0xf
    v_dot2c_f32_bf16_dpp v119, v111, v37 row_newbcast:9 row_mask:0xf bank_mask:0xf
    v_dot2c_f32_bf16_dpp v120, v110, v38 row_newbcast:9 row_mask:0xf bank_mask:0xf
    v_dot2c_f32_bf16_dpp v121, v111, v38 row_newbcast:9 row_mask:0xf bank_mask:0xf
    v_dot2c_f32_bf16_dpp v122, v110, v39 row_newbcast:9 row_mask:0xf bank_mask:0xf
    v_dot2c_f32_bf16_dpp v123, v111, v39 row_newbcast:9 row_mask:0xf bank_mask:0xf
    s_waitcnt vmcnt(5)
    v_dot2c_f32_bf16_dpp v116, v110, v40 row_newbcast:10 row_mask:0xf bank_mask:0xf
    v_dot2c_f32_bf16_dpp v117, v111, v40 row_newbcast:10 row_mask:0xf bank_mask:0xf
    v_dot2c_f32_bf16_dpp v118, v110, v41 row_newbcast:10 row_mask:0xf bank_mask:0xf
    v_dot2c_f32_bf16_dpp v119, v111, v41 row_newbcast:10 row_mask:0xf bank_mask:0xf
    v_dot2c_f32_bf16_dpp v120, v110, v42 row_newbcast:10 row_mask:0xf bank_mask:0xf
    v_dot2c_f32_bf16_dpp v121, v111, v42 row_newbcast:10 row_mask:0xf bank_mask:0xf
    v_dot2c_f32_bf16_dpp v122, v110, v43 row_newbcast:10 row_mask:0xf bank_mask:0xf
    v_dot2c_f32_bf16_dpp v123, v111, v43 row_newbcast:10 row_mask:0xf bank_mask:0xf
    s_waitcnt vmcnt(4)
    v_dot2c_f32_bf16_dpp v116, v110, v44 row_newbcast:11 row_mask:0xf bank_mask:0xf
    v_dot2c_f32_bf16_dpp v117, v111, v44 row_newbcast:11 row_mask:0xf bank_mask:0xf
    v_dot2c_f32_bf16_dpp v118, v110, v45 row_newbcast:11 row_mask:0xf bank_mask:0xf
    v_dot2c_f32_bf16_dpp v119, v111, v45 row_newbcast:11 row_mask:0xf bank_mask:0xf
    v_dot2c_f32_bf16_dpp v120, v110, v46 row_newbcast:11 row_mask:0xf bank_mask:0xf
    v_dot2c_f32_bf16_dpp v121, v111, v46 row_newbcast:11 row_mask:0xf bank_mask:0xf
    v_dot2c_f32_bf16_dpp v122, v110, v47 row_newbcast:11 row_mask:0xf bank_mask:0xf
    v_dot2c_f32_bf16_dpp v123, v111, v47 row_newbcast:11 row_mask:0xf bank_mask:0xf
    s_waitcnt vmcnt(3)
    v_dot2c_f32_bf16_dpp v116, v110, v48 row_newbcast:12 row_mask:0xf bank_mask:0xf
    v_dot2c_f32_bf16_dpp v117, v111, v48 row_newbcast:12 row_mask:0xf bank_mask:0xf
    v_dot2c_f32_bf16_dpp v118, v110, v49 row_newbcast:12 row_mask:0xf bank_mask:0xf
    v_dot2c_f32_bf16_dpp v119, v111, v49 row_newbcast:12 row_mask:0xf bank_mask:0xf
    v_dot2c_f32_bf16_dpp v120, v110, v50 row_newbcast:12 row_mask:0xf bank_mask:0xf
    v_dot2c_f32_bf16_dpp v121, v111, v50 row_newbcast:12 row_mask:0xf bank_mask:0xf
    v_dot2c_f32_bf16_dpp v122, v110, v51 row_newbcast:12 row_mask:0xf bank_mask:0xf
    v_dot2c_f32_bf16_dpp v123, v111, v51 row_newbcast:12 row_mask:0xf bank_mask:0xf
    s_waitcnt vmcnt(2)
    v_dot2c_f32_bf16_dpp v116, v110, v52 row_newbcast:13 row_mask:0xf bank_mask:0xf
    v_dot2c_f32_bf16_dpp v117, v111, v52 row_newbcast:13 row_mask:0xf bank_mask:0xf
    v_dot2c_f32_bf16_dpp v118, v110, v53 row_newbcast:13 row_mask:0xf bank_mask:0xf
    v_dot2c_f32_bf16_dpp v119, v111, v53 row_newbcast:13 row_mask:0xf bank_mask:0xf
    v_dot2c_f32_bf16_dpp v120, v110, v54 row_newbcast:13 row_mask:0xf bank_mask:0xf
    v_dot2c_f32_bf16_dpp v121, v111, v54 row_newbcast:13 row_mask:0xf bank_mask:0xf
    v_dot2c_f32_bf16_dpp v122, v110, v55 row_newbcast:13 row_mask:0xf bank_mask:0xf
    v_dot2c_f32_bf16_dpp v123, v111, v55 row_newbcast:13 row_mask:0xf bank_mask:0xf
    s_waitcnt vmcnt(1)
    v_dot2c_f32_bf16_dpp v116, v110, v56 row_newbcast:14 row_mask:0xf bank_mask:0xf
    v_dot2c_f32_bf16_dpp v117, v111, v56 row_newbcast:14 row_mask:0xf bank_mask:0xf
    v_dot2c_f32_bf16_dpp v118, v110, v57 row_newbcast:14 row_mask:0xf bank_mask:0xf
    v_dot2c_f32_bf16_dpp v119, v111, v57 row_newbcast:14 row_mask:0xf bank_mask:0xf
    v_dot2c_f32_bf16_dpp v120, v110, v58 row_newbcast:14 row_mask:0xf bank_mask:0xf
    v_dot2c_f32_bf16_dpp v121, v111, v58 row_newbcast:14 row_mask:0xf bank_mask:0xf
    v_dot2c_f32_bf16_dpp v122, v110, v59 row_newbcast:14 row_mask:0xf bank_mask:0xf
    v_dot2c_f32_bf16_dpp v123, v111, v59 row_newbcast:14 row_mask:0xf bank_mask:0xf
    s_waitcnt vmcnt(0)
    v_dot2c_f32_bf16_dpp v116, v110, v60 row_newbcast:15 row_mask:0xf bank_mask:0xf
    v_dot2c_f32_bf16_dpp v117, v111, v60 row_newbcast:15 row_mask:0xf bank_mask:0xf
    v_dot2c_f32_bf16_dpp v118, v110, v61 row_newbcast:15 row_mask:0xf bank_mask:0xf
    v_dot2c_f32_bf16_dpp v119, v111, v61 row_newbcast:15 row_mask:0xf bank_mask:0xf
    v_dot2c_f32_bf16_dpp v120, v110, v62 row_newbcast:15 row_mask:0xf bank_mask:0xf
    v_dot2c_f32_bf16_dpp v121, v111, v62 row_newbcast:15 row_mask:0xf bank_mask:0xf
    v_dot2c_f32_bf16_dpp v122, v110, v63 row_newbcast:15 row_mask:0xf bank_mask:0xf
    v_dot2c_f32_bf16_dpp v123, v111, v63 row_newbcast:15 row_mask:0xf bank_mask:0xf
    v_permlane32_swap_b32 v116, v120
    v_permlane32_swap_b32 v117, v121
    v_permlane32_swap_b32 v118, v122
    v_permlane32_swap_b32 v119, v123
    v_add_f32 v116, v116, v120
    v_add_f32 v117, v117, v121
    v_add_f32 v118, v118, v122
    v_add_f32 v119, v119, v123
    s_nop 0
    v_permlane16_swap_b32 v116, v118
    v_permlane16_swap_b32 v117, v119
    v_add_f32 v116, v116, v118
    v_add_f32 v117, v117, v119
    v_mul_f32 v116, v101, v116
    v_mul_f32 v117, v101, v117
    ds_write_b64 v104, v[116:117] offset:1024
    s_nop 3
L_barA:
    v_and_b32 v106, 7, v125
    v_mul_u32_u24 v106, 544, v106
    v_bfe_u32 v107, v125, 3, 2
    v_lshl_add_u32 v106, v107, 3, v106
    s_lshl_b32 s38, s34, 5
    v_add_u32 v106, s38, v106
    s_lshl_b32 s38, s34, 4
    v_lshl_add_u32 v107, v107, 2, s38
    s_mov_b32 s38, 0x01010101
    s_mov_b32 s39, 0
    s_waitcnt lgkmcnt(0)
    s_barrier
    ds_read_b64 v[108:109], v106 offset:1024
    s_waitcnt lgkmcnt(0)
    v_add_f32_dpp v108, v108, v108 quad_perm:[1,0,3,2] row_mask:0xf bank_mask:0xf
    v_add_f32_dpp v109, v109, v109 quad_perm:[1,0,3,2] row_mask:0xf bank_mask:0xf
    s_nop 0
    v_add_f32_dpp v108, v108, v108 quad_perm:[2,3,0,1] row_mask:0xf bank_mask:0xf
    v_add_f32_dpp v109, v109, v109 quad_perm:[2,3,0,1] row_mask:0xf bank_mask:0xf
    s_nop 0
    v_add_f32_dpp v108, v108, v108 row_half_mirror row_mask:0xf bank_mask:0xf
    v_add_f32_dpp v109, v109, v109 row_half_mirror row_mask:0xf bank_mask:0xf
    v_cvt_pk_bf16_f32 v108, v108, v109
    s_mov_b64 exec, s[38:39]
    ds_write_b32 v107, v108 offset:512
    s_mov_b64 exec, -1
    s_waitcnt lgkmcnt(0)
    s_barrier
    s_cmp_ge_u32 s34, 8
    s_cbranch_scc1 L_yphase
    s_branch L_pubdone
L_yphase:
    ds_read_b128 v[72:75], v105 offset:512
    ds_read_b128 v[76:79], v105 offset:528
    s_waitcnt lgkmcnt(0)
    v_dot2c_f32_bf16 v80, v72, v64
    v_dot2c_f32_bf16 v81, v72, v4
    v_dot2c_f32_bf16 v82, v72, v65
    v_dot2c_f32_bf16 v83, v72, v5
    v_dot2c_f32_bf16 v84, v72, v66
    v_dot2c_f32_bf16 v85, v72, v6
    v_dot2c_f32_bf16 v86, v72, v67
    v_dot2c_f32_bf16 v87, v72, v7
    v_dot2c_f32_bf16 v80, v73, v0
    v_dot2c_f32_bf16 v81, v73, v12
    v_dot2c_f32_bf16 v82, v73, v1
    v_dot2c_f32_bf16 v83, v73, v13
    v_dot2c_f32_bf16 v84, v73, v2
    v_dot2c_f32_bf16 v85, v73, v14
    v_dot2c_f32_bf16 v86, v73, v3
    v_dot2c_f32_bf16 v87, v73, v15
    v_dot2c_f32_bf16 v80, v74, v8
    v_dot2c_f32_bf16 v81, v74, v20
    v_dot2c_f32_bf16 v82, v74, v9
    v_dot2c_f32_bf16 v83, v74, v21
    v_dot2c_f32_bf16 v84, v74, v10
    v_dot2c_f32_bf16 v85, v74, v22
    v_dot2c_f32_bf16 v86, v74, v11
    v_dot2c_f32_bf16 v87, v74, v23
    v_dot2c_f32_bf16 v80, v75, v16
    v_dot2c_f32_bf16 v81, v75, v28
    v_dot2c_f32_bf16 v82, v75, v17
    v_dot2c_f32_bf16 v83, v75, v29
    v_dot2c_f32_bf16 v84, v75, v18
    v_dot2c_f32_bf16 v85, v75, v30
    v_dot2c_f32_bf16 v86, v75, v19
    v_dot2c_f32_bf16 v87, v75, v31
    v_dot2c_f32_bf16 v80, v76, v24
    v_dot2c_f32_bf16 v81, v76, v36
    v_dot2c_f32_bf16 v82, v76, v25
    v_dot2c_f32_bf16 v83, v76, v37
    v_dot2c_f32_bf16 v84, v76, v26
    v_dot2c_f32_bf16 v85, v76, v38
    v_dot2c_f32_bf16 v86, v76, v27
    v_dot2c_f32_bf16 v87, v76, v39
    v_dot2c_f32_bf16 v80, v77, v32
    v_dot2c_f32_bf16 v81, v77, v44
    v_dot2c_f32_bf16 v82, v77, v33
    v_dot2c_f32_bf16 v83, v77, v45
    v_dot2c_f32_bf16 v84, v77, v34
    v_dot2c_f32_bf16 v85, v77, v46
    v_dot2c_f32_bf16 v86, v77, v35
    v_dot2c_f32_bf16 v87, v77, v47
    v_dot2c_f32_bf16 v80, v78, v40
    v_dot2c_f32_bf16 v81, v78, v52
    v_dot2c_f32_bf16 v82, v78, v41
    v_dot2c_f32_bf16 v83, v78, v53
    v_dot2c_f32_bf16 v84, v78, v42
    v_dot2c_f32_bf16 v85, v78, v54
    v_dot2c_f32_bf16 v86, v78, v43
    v_dot2c_f32_bf16 v87, v78, v55
    v_dot2c_f32_bf16 v80, v79, v48
    v_dot2c_f32_bf16 v81, v79, v60
    v_dot2c_f32_bf16 v82, v79, v49
    v_dot2c_f32_bf16 v83, v79, v61
    v_dot2c_f32_bf16 v84, v79, v50
    v_dot2c_f32_bf16 v85, v79, v62
    v_dot2c_f32_bf16 v86, v79, v51
    v_dot2c_f32_bf16 v87, v79, v63
    v_permlane32_swap_b32 v80, v84
    v_permlane32_swap_b32 v81, v85
    v_permlane32_swap_b32 v82, v86
    v_permlane32_swap_b32 v83, v87
    v_add_f32 v80, v80, v84
    v_add_f32 v81, v81, v85
    v_add_f32 v82, v82, v86
    v_add_f32 v83, v83, v87
    s_nop 0
    v_permlane16_swap_b32 v80, v82
    v_permlane16_swap_b32 v81, v83
    v_add_f32 v88, v80, v82
    v_add_f32 v89, v81, v83
    s_nop 0
    v_add_f32_dpp v88, v88, v88 row_ror:8 row_mask:0xf bank_mask:0xf
    v_add_f32_dpp v89, v89, v89 row_ror:8 row_mask:0xf bank_mask:0xf
    buffer_store_dwordx4 v[88:91], v92, s[60:63], s79 offen sc1
    s_nop 3
L_pubdone:
    s_cmp_ge_u32 s2, 32
    s_cbranch_scc1 L_fin
    s_lshl_b32 s38, s34, 6
    v_add_u32 v99, s38, v125
    v_lshlrev_b32 v98, 5, v99
    v_lshrrev_b32 v97, 2, v99
    v_lshlrev_b32 v97, 4, v97
    s_lshl_b32 s38, s2, 14
    s_add_u32 s38, s38, 524288
    s_add_u32 s52, s32, s38
    s_addc_u32 s53, s33, 0
    s_mov_b32 s54, 11008
    s_mov_b32 s55, 0x20000
    s_lshl_b32 s38, s2, 15
    s_add_u32 s38, s38, 1048576
    s_mov_b32 s39, 458752
    ds_read_b64 v[24:25], v127 offset:832
    s_mov_b32 s79, 0x158
    v_cmp_gt_u32 s[72:73], s79, v99
    s_mov_b32 s75, 65536
    s_nop 3
L_mlpoll:
    buffer_load_dwordx4 v[8:11], v97, s[60:63], s39 offen sc1
    buffer_load_dwordx4 v[12:15], v98, s[52:55], 0 offen sc1
    buffer_load_dwordx4 v[16:19], v98, s[52:55], 0 offen offset:16 sc1
    s_waitcnt vmcnt(0)
    v_xor_b32 v20, s4, v14
    v_xor_b32 v21, s5, v15
    v_or_b32 v20, v20, v21
    v_xor_b32 v21, s4, v18
    v_or_b32 v20, v20, v21
    v_xor_b32 v21, s5, v19
    v_or_b32 v20, v20, v21
    v_cmp_ne_u32 vcc, 0, v20
    s_nop 1
    s_and_b64 s[76:77], vcc, s[72:73]
    v_xor_b32 v20, s4, v10
    v_xor_b32 v21, s5, v11
    v_or_b32 v20, v20, v21
    v_cmp_ne_u32 vcc, 0, v20
    s_nop 1
    s_or_b64 s[76:77], s[76:77], vcc
    s_cmp_eq_u64 s[76:77], 0
    s_cbranch_scc1 L_mlok
    s_sub_u32 s75, s75, 1
    s_cmp_eq_u32 s75, 0
    s_cbranch_scc1 L_end
    s_sleep 2
L_mlpoll2:
    buffer_load_dwordx4 v[8:11], v97, s[60:63], s39 offen sc1
    s_waitcnt vmcnt(0)
    v_xor_b32 v20, s4, v10
    v_xor_b32 v21, s5, v11
    v_or_b32 v20, v20, v21
    v_cmp_ne_u32 vcc, 0, v20
    s_nop 3
    s_nop 0
    s_cbranch_vccnz L_mlretry
    s_branch L_mlpoll
L_mlretry:
    s_sub_u32 s75, s75, 1
    s_cmp_eq_u32 s75, 0
    s_cbranch_scc1 L_end
    s_sleep 2
    s_branch L_mlpoll2
L_mlok:
    buffer_load_dwordx4 v[0:3], v98, s[60:63], s38 offen sc1
    buffer_load_dwordx4 v[4:7], v98, s[60:63], s38 offen offset:16 sc1
    v_mov_b32 v26, v8
    s_nop 1
    v_max_f32_dpp v26, v26, v26 row_ror:4 row_mask:0xf bank_mask:0xf
    s_nop 1
    v_max_f32_dpp v26, v26, v26 row_ror:8 row_mask:0xf bank_mask:0xf
    v_mov_b32 v27, v26
    s_nop 1
    v_permlane16_swap_b32 v26, v27
    v_max_f32 v26, v26, v27
    v_sub_f32 v26, v8, v26
    v_exp_f32 v26, v26
    s_nop 0
    v_mul_f32 v28, v26, v9
    s_nop 1
    v_add_f32_dpp v28, v28, v28 row_ror:4 row_mask:0xf bank_mask:0xf
    s_nop 1
    v_add_f32_dpp v28, v28, v28 row_ror:8 row_mask:0xf bank_mask:0xf
    v_mov_b32 v27, v28
    s_nop 1
    v_permlane16_swap_b32 v28, v27
    v_add_f32 v28, v28, v27
    v_rcp_f32 v28, v28
    s_waitcnt lgkmcnt(0)
    v_mul_f32 v26, v26, v24
    v_mul_f32 v26, v26, v28
    v_mul_f32 v12, v25, v12
    v_mul_f32 v13, v25, v13
    v_mul_f32 v16, v25, v16
    v_mul_f32 v17, v25, v17
    v_and_b32 v46, 3, v125
    v_lshlrev_b32 v46, 4, v46
    v_lshrrev_b32 v47, 4, v125
    v_lshl_add_u32 v46, v47, 2, v46
    s_lshl_b32 s79, s34, 6
    v_add_u32 v47, s79, v46
    s_nop 3
L_rpoll:
    s_waitcnt vmcnt(0)
    v_xor_b32 v20, s4, v2
    v_xor_b32 v21, s5, v3
    v_or_b32 v20, v20, v21
    v_xor_b32 v21, s4, v6
    v_or_b32 v20, v20, v21
    v_xor_b32 v21, s5, v7
    v_or_b32 v20, v20, v21
    v_cmp_ne_u32 vcc, 0, v20
    s_nop 3
    s_nop 0
    s_cbranch_vccz L_rokA
    buffer_load_dwordx4 v[0:3], v98, s[60:63], s38 offen sc1
    buffer_load_dwordx4 v[4:7], v98, s[60:63], s38 offen offset:16 sc1
    s_sub_u32 s75, s75, 1
    s_cmp_eq_u32 s75, 0
    s_cbranch_scc1 L_end
    s_branch L_rpoll
L_rokB:
    v_fma_f32 v40, v26, v32, v12
    v_fma_f32 v41, v26, v33, v13
    v_fma_f32 v42, v26, v36, v16
    v_fma_f32 v43, v26, v37, v17
    s_nop 3
    s_branch L_rok
L_rokA:
    v_fma_f32 v40, v26, v0, v12
    v_fma_f32 v41, v26, v1, v13
    v_fma_f32 v42, v26, v4, v16
    v_fma_f32 v43, v26, v5, v17
    s_nop 3
L_rok:
    v_add_f32_dpp v40, v40, v40 row_ror:4 row_mask:0xf bank_mask:0xf
    v_add_f32_dpp v41, v41, v41 row_ror:4 row_mask:0xf bank_mask:0xf
    v_add_f32_dpp v42, v42, v42 row_ror:4 row_mask:0xf bank_mask:0xf
    v_add_f32_dpp v43, v43, v43 row_ror:4 row_mask:0xf bank_mask:0xf
    v_add_f32_dpp v40, v40, v40 row_ror:8 row_mask:0xf bank_mask:0xf
    v_add_f32_dpp v41, v41, v41 row_ror:8 row_mask:0xf bank_mask:0xf
    v_add_f32_dpp v42, v42, v42 row_ror:8 row_mask:0xf bank_mask:0xf
    v_add_f32_dpp v43, v43, v43 row_ror:8 row_mask:0xf bank_mask:0xf
    s_nop 0
    v_permlane32_swap_b32 v40, v42
    v_permlane32_swap_b32 v41, v43
    v_add_f32 v40, v40, v42
    v_add_f32 v41, v41, v43
    s_nop 1
    v_permlane16_swap_b32 v40, v41
    v_add_f32 v40, v40, v41
    s_mov_b32 s38, 0x000f000f
    s_mov_b32 s39, 0x000f000f
    s_mov_b64 exec, s[38:39]
    ds_write_b32 v47, v40 offset:5376
    s_mov_b64 exec, -1
    s_waitcnt lgkmcnt(0)
    s_barrier
    s_cmp_lg_u32 s34, 0
    s_cbranch_scc1 L_fin
    v_lshlrev_b32 v47, 4, v125
    ds_read_b128 v[40:43], v47 offset:5376
    v_lshrrev_b32 v46, 1, v46
    s_lshl_b32 s79, s2, 5
    s_mov_b32 s52, s28
    s_mov_b32 s53, s29
    s_mov_b32 s54, 1024
    s_mov_b32 s55, 0x20000
    v_mov_b32 v44, s4
    s_waitcnt lgkmcnt(0)
    v_add_f32_dpp v40, v40, v40 row_ror:4 row_mask:0xf bank_mask:0xf
    v_add_f32_dpp v41, v41, v41 row_ror:4 row_mask:0xf bank_mask:0xf
    v_add_f32_dpp v42, v42, v42 row_ror:4 row_mask:0xf bank_mask:0xf
    v_add_f32_dpp v43, v43, v43 row_ror:4 row_mask:0xf bank_mask:0xf
    v_add_f32_dpp v40, v40, v40 row_ror:8 row_mask:0xf bank_mask:0xf
    v_add_f32_dpp v41, v41, v41 row_ror:8 row_mask:0xf bank_mask:0xf
    v_add_f32_dpp v42, v42, v42 row_ror:8 row_mask:0xf bank_mask:0xf
    v_add_f32_dpp v43, v43, v43 row_ror:8 row_mask:0xf bank_mask:0xf
    s_nop 0
    v_permlane32_swap_b32 v40, v42
    v_permlane32_swap_b32 v41, v43
    v_add_f32 v40, v40, v42
    v_add_f32 v41, v41, v43
    s_nop 1
    v_permlane16_swap_b32 v40, v41
    v_add_f32 v40, v40, v41
    v_cvt_pk_bf16_f32 v40, v40, 0
    s_mov_b64 exec, s[38:39]
    buffer_store_short v40, v46, s[52:55], s79 offen
    s_cmp_lg_u32 s2, 0
    s_nop 3
    s_cbranch_scc1 L_fin
    s_mov_b64 exec, 1
    s_mov_b32 s38, 520192
    buffer_store_dword v44, v127, s[60:63], s38 offen sc1
L_fin:
    s_mov_b64 exec, -1
L_end:
    s_endpgm
L_svc:
    s_mov_b32 s60, s32
    s_mov_b32 s61, s33
    s_mov_b32 s62, 3145728
    s_mov_b32 s63, 0x20000
    s_load_dword s6, s[32:33], 520192
    s_cmp_eq_u32 s34, 9
    s_cbranch_scc1 L_b1
    s_cmp_eq_u32 s34, 10
    s_cbranch_scc1 L_b2
    s_cmp_eq_u32 s34, 11
    s_cbranch_scc1 L_gate
    s_cmp_lg_u32 s34, 8
    s_cbranch_scc1 L_wo
    s_lshl_b32 s38, s36, 19
    s_lshl_b32 s39, s35, 8
    s_add_u32 s38, s38, s39
    s_add_u32 s52, s14, s38
    s_addc_u32 s53, s15, 0
    s_sub_u32 s54, 0x400000, s38
    s_mov_b32 s55, 0x20000
    v_lshrrev_b32 v122, 4, v125
    v_and_b32 v121, 15, v125
    v_lshlrev_b32 v120, 17, v122
    v_lshl_add_u32 v120, v121, 4, v120
    v_lshlrev_b32 v119, 5, v122
    s_lshl_b32 s38, s36, 7
    v_add_u32 v119, s38, v119
    global_load_dwordx4 v[64:67], v119, s[8:9]
    global_load_dwordx4 v[68:71], v119, s[8:9] offset:16
    buffer_load_dwordx4 v[0:3], v120, s[52:55], 0 offen nt
    v_add_u32 v120, 0x2000, v120
    buffer_load_dwordx4 v[4:7], v120, s[52:55], 0 offen nt
    v_add_u32 v120, 0x2000, v120
    buffer_load_dwordx4 v[8:11], v120, s[52:55], 0 offen nt
    v_add_u32 v120, 0x2000, v120
    buffer_load_dwordx4 v[12:15], v120, s[52:55], 0 offen nt
    v_add_u32 v120, 0x2000, v120
    buffer_load_dwordx4 v[16:19], v120, s[52:55], 0 offen nt
    v_add_u32 v120, 0x2000, v120
    buffer_load_dwordx4 v[20:23], v120, s[52:55], 0 offen nt
    v_add_u32 v120, 0x2000, v120
    buffer_load_dwordx4 v[24:27], v120, s[52:55], 0 offen nt
    v_add_u32 v120, 0x2000, v120
    buffer_load_dwordx4 v[28:31], v120, s[52:55], 0 offen nt
    v_add_u32 v120, 0x2000, v120
    buffer_load_dwordx4 v[32:35], v120, s[52:55], 0 offen nt
    v_add_u32 v120, 0x2000, v120
    buffer_load_dwordx4 v[36:39], v120, s[52:55], 0 offen nt
    v_add_u32 v120, 0x2000, v120
    buffer_load_dwordx4 v[40:43], v120, s[52:55], 0 offen nt
    v_add_u32 v120, 0x2000, v120
    buffer_load_dwordx4 v[44:47], v120, s[52:55], 0 offen nt
    v_add_u32 v120, 0x2000, v120
    buffer_load_dwordx4 v[48:51], v120, s[52:55], 0 offen nt
    v_add_u32 v120, 0x2000, v120
    buffer_load_dwordx4 v[52:55], v120, s[52:55], 0 offen nt
    v_add_u32 v120, 0x2000, v120
    buffer_load_dwordx4 v[56:59], v120, s[52:55], 0 offen nt
    v_add_u32 v120, 0x2000, v120
    buffer_load_dwordx4 v[60:63], v120, s[52:55], 0 offen nt
    v_mov_b32 v104, 0
    v_mov_b32 v105, 0
    v_mov_b32 v106, 0
    v_mov_b32 v107, 0
    v_mov_b32 v108, 0
    v_mov_b32 v109, 0
    v_mov_b32 v110, 0
    v_mov_b32 v111, 0
    s_waitcnt vmcnt(16)
    v_and_b32 v72, 0xffff, v64
    v_lshlrev_b32 v73, 16, v64
    v_lshrrev_b32 v74, 16, v64
    v_and_b32 v75, 0xffff0000, v64
    v_and_b32 v76, 0xffff, v65
    v_lshlrev_b32 v77, 16, v65
    v_lshrrev_b32 v78, 16, v65
    v_and_b32 v79, 0xffff0000, v65
    v_and_b32 v80, 0xffff, v66
    v_lshlrev_b32 v81, 16, v66
    v_lshrrev_b32 v82, 16, v66
    v_and_b32 v83, 0xffff0000, v66
    v_and_b32 v84, 0xffff, v67
    v_lshlrev_b32 v85, 16, v67
    v_lshrrev_b32 v86, 16, v67
    v_and_b32 v87, 0xffff0000, v67
    v_and_b32 v88, 0xffff, v68
    v_lshlrev_b32 v89, 16, v68
    v_lshrrev_b32 v90, 16, v68
    v_and_b32 v91, 0xffff0000, v68
    v_and_b32 v92, 0xffff, v69
    v_lshlrev_b32 v93, 16, v69
    v_lshrrev_b32 v94, 16, v69
    v_and_b32 v95, 0xffff0000, v69
    v_and_b32 v96, 0xffff, v70
    v_lshlrev_b32 v97, 16, v70
    v_lshrrev_b32 v98, 16, v70
    v_and_b32 v99, 0xffff0000, v70
    v_and_b32 v100, 0xffff, v71
    v_lshlrev_b32 v101, 16, v71
    v_lshrrev_b32 v102, 16, v71
    v_and_b32 v103, 0xffff0000, v71
    s_waitcnt vmcnt(15)
    v_dot2c_f32_bf16 v104, v72, v0
    v_dot2c_f32_bf16 v105, v73, v0
    v_dot2c_f32_bf16 v106, v72, v1
    v_dot2c_f32_bf16 v107, v73, v1
    v_dot2c_f32_bf16 v108, v72, v2
    v_dot2c_f32_bf16 v109, v73, v2
    v_dot2c_f32_bf16 v110, v72, v3
    v_dot2c_f32_bf16 v111, v73, v3
    s_waitcnt vmcnt(14)
    v_dot2c_f32_bf16 v104, v74, v4
    v_dot2c_f32_bf16 v105, v75, v4
    v_dot2c_f32_bf16 v106, v74, v5
    v_dot2c_f32_bf16 v107, v75, v5
    v_dot2c_f32_bf16 v108, v74, v6
    v_dot2c_f32_bf16 v109, v75, v6
    v_dot2c_f32_bf16 v110, v74, v7
    v_dot2c_f32_bf16 v111, v75, v7
    s_waitcnt vmcnt(13)
    v_dot2c_f32_bf16 v104, v76, v8
    v_dot2c_f32_bf16 v105, v77, v8
    v_dot2c_f32_bf16 v106, v76, v9
    v_dot2c_f32_bf16 v107, v77, v9
    v_dot2c_f32_bf16 v108, v76, v10
    v_dot2c_f32_bf16 v109, v77, v10
    v_dot2c_f32_bf16 v110, v76, v11
    v_dot2c_f32_bf16 v111, v77, v11
    s_waitcnt vmcnt(12)
    v_dot2c_f32_bf16 v104, v78, v12
    v_dot2c_f32_bf16 v105, v79, v12
    v_dot2c_f32_bf16 v106, v78, v13
    v_dot2c_f32_bf16 v107, v79, v13
    v_dot2c_f32_bf16 v108, v78, v14
    v_dot2c_f32_bf16 v109, v79, v14
    v_dot2c_f32_bf16 v110, v78, v15
    v_dot2c_f32_bf16 v111, v79, v15
    s_waitcnt vmcnt(11)
    v_dot2c_f32_bf16 v104, v80, v16
    v_dot2c_f32_bf16 v105, v81, v16
    v_dot2c_f32_bf16 v106, v80, v17
    v_dot2c_f32_bf16 v107, v81, v17
    v_dot2c_f32_bf16 v108, v80, v18
    v_dot2c_f32_bf16 v109, v81, v18
    v_dot2c_f32_bf16 v110, v80, v19
    v_dot2c_f32_bf16 v111, v81, v19
    s_waitcnt vmcnt(10)
    v_dot2c_f32_bf16 v104, v82, v20
    v_dot2c_f32_bf16 v105, v83, v20
    v_dot2c_f32_bf16 v106, v82, v21
    v_dot2c_f32_bf16 v107, v83, v21
    v_dot2c_f32_bf16 v108, v82, v22
    v_dot2c_f32_bf16 v109, v83, v22
    v_dot2c_f32_bf16 v110, v82, v23
    v_dot2c_f32_bf16 v111, v83, v23
    s_waitcnt vmcnt(9)
    v_dot2c_f32_bf16 v104, v84, v24
    v_dot2c_f32_bf16 v105, v85, v24
    v_dot2c_f32_bf16 v106, v84, v25
    v_dot2c_f32_bf16 v107, v85, v25
    v_dot2c_f32_bf16 v108, v84, v26
    v_dot2c_f32_bf16 v109, v85, v26
    v_dot2c_f32_bf16 v110, v84, v27
    v_dot2c_f32_bf16 v111, v85, v27
    s_waitcnt vmcnt(8)
    v_dot2c_f32_bf16 v104, v86, v28
    v_dot2c_f32_bf16 v105, v87, v28
    v_dot2c_f32_bf16 v106, v86, v29
    v_dot2c_f32_bf16 v107, v87, v29
    v_dot2c_f32_bf16 v108, v86, v30
    v_dot2c_f32_bf16 v109, v87, v30
    v_dot2c_f32_bf16 v110, v86, v31
    v_dot2c_f32_bf16 v111, v87, v31
    s_waitcnt vmcnt(7)
    v_dot2c_f32_bf16 v104, v88, v32
    v_dot2c_f32_bf16 v105, v89, v32
    v_dot2c_f32_bf16 v106, v88, v33
    v_dot2c_f32_bf16 v107, v89, v33
    v_dot2c_f32_bf16 v108, v88, v34
    v_dot2c_f32_bf16 v109, v89, v34
    v_dot2c_f32_bf16 v110, v88, v35
    v_dot2c_f32_bf16 v111, v89, v35
    s_waitcnt vmcnt(6)
    v_dot2c_f32_bf16 v104, v90, v36
    v_dot2c_f32_bf16 v105, v91, v36
    v_dot2c_f32_bf16 v106, v90, v37
    v_dot2c_f32_bf16 v107, v91, v37
    v_dot2c_f32_bf16 v108, v90, v38
    v_dot2c_f32_bf16 v109, v91, v38
    v_dot2c_f32_bf16 v110, v90, v39
    v_dot2c_f32_bf16 v111, v91, v39
    s_waitcnt vmcnt(5)
    v_dot2c_f32_bf16 v104, v92, v40
    v_dot2c_f32_bf16 v105, v93, v40
    v_dot2c_f32_bf16 v106, v92, v41
    v_dot2c_f32_bf16 v107, v93, v41
    v_dot2c_f32_bf16 v108, v92, v42
    v_dot2c_f32_bf16 v109, v93, v42
    v_dot2c_f32_bf16 v110, v92, v43
    v_dot2c_f32_bf16 v111, v93, v43
    s_waitcnt vmcnt(4)
    v_dot2c_f32_bf16 v104, v94, v44
    v_dot2c_f32_bf16 v105, v95, v44
    v_dot2c_f32_bf16 v106, v94, v45
    v_dot2c_f32_bf16 v107, v95, v45
    v_dot2c_f32_bf16 v108, v94, v46
    v_dot2c_f32_bf16 v109, v95, v46
    v_dot2c_f32_bf16 v110, v94, v47
    v_dot2c_f32_bf16 v111, v95, v47
    s_waitcnt vmcnt(3)
    v_dot2c_f32_bf16 v104, v96, v48
    v_dot2c_f32_bf16 v105, v97, v48
    v_dot2c_f32_bf16 v106, v96, v49
    v_dot2c_f32_bf16 v107, v97, v49
    v_dot2c_f32_bf16 v108, v96, v50
    v_dot2c_f32_bf16 v109, v97, v50
    v_dot2c_f32_bf16 v110, v96, v51
    v_dot2c_f32_bf16 v111, v97, v51
    s_waitcnt vmcnt(2)
    v_dot2c_f32_bf16 v104, v98, v52
    v_dot2c_f32_bf16 v105, v99, v52
    v_dot2c_f32_bf16 v106, v98, v53
    v_dot2c_f32_bf16 v107, v99, v53
    v_dot2c_f32_bf16 v108, v98, v54
    v_dot2c_f32_bf16 v109, v99, v54
    v_dot2c_f32_bf16 v110, v98, v55
    v_dot2c_f32_bf16 v111, v99, v55
    s_waitcnt vmcnt(1)
    v_dot2c_f32_bf16 v104, v100, v56
    v_dot2c_f32_bf16 v105, v101, v56
    v_dot2c_f32_bf16 v106, v100, v57
    v_dot2c_f32_bf16 v107, v101, v57
    v_dot2c_f32_bf16 v108, v100, v58
    v_dot2c_f32_bf16 v109, v101, v58
    v_dot2c_f32_bf16 v110, v100, v59
    v_dot2c_f32_bf16 v111, v101, v59
    s_waitcnt vmcnt(0)
    v_dot2c_f32_bf16 v104, v102, v60
    v_dot2c_f32_bf16 v105, v103, v60
    v_dot2c_f32_bf16 v106, v102, v61
    v_dot2c_f32_bf16 v107, v103, v61
    v_dot2c_f32_bf16 v108, v102, v62
    v_dot2c_f32_bf16 v109, v103, v62
    v_dot2c_f32_bf16 v110, v102, v63
    v_dot2c_f32_bf16 v111, v103, v63
    v_permlane32_swap_b32 v104, v108
    v_permlane32_swap_b32 v105, v109
    v_permlane32_swap_b32 v106, v110
    v_permlane32_swap_b32 v107, v111
    v_add_f32 v104, v104, v108
    v_add_f32 v105, v105, v109
    v_add_f32 v106, v106, v110
    v_add_f32 v107, v107, v111
    s_nop 0
    v_permlane16_swap_b32 v104, v106
    v_permlane16_swap_b32 v105, v107
    v_add_f32 v104, v104, v106
    v_add_f32 v105, v105, v107
    s_waitcnt lgkmcnt(0)
    s_add_u32 s4, s6, 1
    s_mul_i32 s5, s4, 0x9e3779b1
    s_xor_b32 s5, s5, 0x5bd1e995
    v_mov_b32 v106, s4
    v_mov_b32 v107, s5
    v_lshlrev_b32 v119, 6, v121
    v_lshl_add_u32 v119, v122, 4, v119
    s_lshl_b32 s79, s37, 10
    buffer_store_dwordx4 v[104:107], v119, s[60:63], s79 offen sc1
    s_waitcnt vmcnt(0)
    v_lshlrev_b32 v119, 4, v125
    s_lshl_b32 s79, s35, 13
    s_add_u32 s38, s79, 4096
    s_mov_b32 s75, 65536
    s_nop 3
L_qpoll:
    buffer_load_dwordx4 v[0:3], v119, s[60:63], s79 offen offset:0 sc1
    buffer_load_dwordx4 v[4:7], v119, s[60:63], s79 offen offset:1024 sc1
    buffer_load_dwordx4 v[8:11], v119, s[60:63], s79 offen offset:2048 sc1
    buffer_load_dwordx4 v[12:15], v119, s[60:63], s79 offen offset:3072 sc1
    buffer_load_dwordx4 v[16:19], v119, s[60:63], s38 offen offset:0 sc1
    buffer_load_dwordx4 v[20:23], v119, s[60:63], s38 offen offset:1024 sc1
    buffer_load_dwordx4 v[24:27], v119, s[60:63], s38 offen offset:2048 sc1
    buffer_load_dwordx4 v[28:31], v119, s[60:63], s38 offen offset:3072 sc1
    s_waitcnt vmcnt(0)
    v_xor_b32 v32, s4, v2
    v_xor_b32 v33, s5, v3
    v_or_b32 v32, v32, v33
    v_xor_b32 v33, s4, v6
    v_or_b32 v32, v32, v33
    v_xor_b32 v33, s5, v7
    v_or_b32 v32, v32, v33
    v_xor_b32 v33, s4, v10
    v_or_b32 v32, v32, v33
    v_xor_b32 v33, s5, v11
    v_or_b32 v32, v32, v33
    v_xor_b32 v33, s4, v14
    v_or_b32 v32, v32, v33
    v_xor_b32 v33, s5, v15
    v_or_b32 v32, v32, v33
    v_xor_b32 v33, s4, v18
    v_or_b32 v32, v32, v33
    v_xor_b32 v33, s5, v19
    v_or_b32 v32, v32, v33
    v_xor_b32 v33, s4, v22
    v_or_b32 v32, v32, v33
    v_xor_b32 v33, s5, v23
    v_or_b32 v32, v32, v33
    v_xor_b32 v33, s4, v26
    v_or_b32 v32, v32, v33
    v_xor_b32 v33, s5, v27
    v_or_b32 v32, v32, v33
    v_xor_b32 v33, s4, v30
    v_or_b32 v32, v32, v33
    v_xor_b32 v33, s5, v31
    v_or_b32 v32, v32, v33
    v_cmp_ne_u32 vcc, 0, v32
    s_nop 3
    s_nop 0
    s_cbranch_vccz L_qok
    s_sub_u32 s75, s75, 1
    s_cmp_eq_u32 s75, 0
    s_cbranch_scc1 L_end
    s_branch L_qpoll
L_qok:
    v_add_f32 v0, v0, v4
    v_add_f32 v8, v8, v12
    v_add_f32 v16, v16, v20
    v_add_f32 v24, v24, v28
    v_add_f32 v1, v1, v5
    v_add_f32 v9, v9, v13
    v_add_f32 v17, v17, v21
    v_add_f32 v25, v25, v29
    v_add_f32 v0, v0, v8
    v_add_f32 v16, v16, v24
    v_add_f32 v1, v1, v9
    v_add_f32 v17, v17, v25
    v_add_f32 v0, v0, v16
    v_add_f32 v1, v1, v17
    v_cvt_pk_bf16_f32 v0, v0, v1
    v_lshlrev_b32 v119, 2, v125
    ds_write_b32 v119, v0 offset:256
    s_waitcnt lgkmcnt(0)
    s_mov_b64 exec, 1
    v_mov_b32 v126, 1
    ds_write_b32 v127, v126 offset:8
    s_mov_b64 exec, -1
    s_nop 3
    s_branch L_wo2
L_b1:
    s_cmp_ge_u32 s2, 172
    s_cbranch_scc1 L_wo
    s_and_b32 s38, s2, 3
    s_mul_i32 s39, s38, 352256
    s_lshr_b32 s79, s2, 2
    s_lshl_b32 s74, s79, 7
    s_add_u32 s39, s39, s74
    s_add_u32 s52, s20, s39
    s_addc_u32 s53, s21, 0
    s_sub_u32 s54, 1409024, s39
    s_mov_b32 s55, 0x20000
    s_add_u32 s48, s22, s39
    s_addc_u32 s49, s23, 0
    s_mov_b32 s50, s54
    s_mov_b32 s51, 0x20000
    v_lshrrev_b32 v122, 3, v125
    v_and_b32 v121, 7, v125
    v_mul_u32_u24 v120, 44032, v122
    v_lshl_add_u32 v120, v121, 4, v120
    v_lshlrev_b32 v119, 5, v122
    s_lshl_b32 s38, s38, 8
    v_add_u32 v119, s38, v119
    global_load_dwordx4 v[64:67], v119, s[8:9]
    global_load_dwordx4 v[68:71], v119, s[8:9] offset:16
    s_lshl_b32 s74, s79, 6
    v_lshl_add_u32 v118, v121, 3, s74
    s_movk_i32 s74, 1375
    v_cmp_lt_u32 vcc, s74, v118
    s_nop 1
    v_cndmask_b32 v118, 0, 16, vcc
    buffer_load_dwordx4 v[0:3], v120, s[52:55], 0 offen nt
    buffer_load_dwordx4 v[32:35], v120, s[48:51], 0 offen nt
    v_add_u32 v120, 5504, v120
    buffer_load_dwordx4 v[4:7], v120, s[52:55], 0 offen nt
    buffer_load_dwordx4 v[36:39], v120, s[48:51], 0 offen nt
    v_add_u32 v120, 5504, v120
    s_waitcnt vmcnt(3)
    buffer_load_dwordx4 v[8:11], v120, s[52:55], 0 offen nt
    s_waitcnt vmcnt(3)
    buffer_load_dwordx4 v[40:43], v120, s[48:51], 0 offen nt
    v_add_u32 v120, 5504, v120
    s_waitcnt vmcnt(3)
    buffer_load_dwordx4 v[12:15], v120, s[52:55], 0 offen nt
    s_waitcnt vmcnt(3)
    buffer_load_dwordx4 v[44:47], v120, s[48:51], 0 offen nt
    v_add_u32 v120, 5504, v120
    s_waitcnt vmcnt(3)
    buffer_load_dwordx4 v[16:19], v120, s[52:55], 0 offen nt
    s_waitcnt vmcnt(3)
    buffer_load_dwordx4 v[48:51], v120, s[48:51], 0 offen nt
    v_add_u32 v120, 5504, v120
    s_waitcnt vmcnt(3)
    buffer_load_dwordx4 v[20:23], v120, s[52:55], 0 offen nt
    s_waitcnt vmcnt(3)
    buffer_load_dwordx4 v[52:55], v120, s[48:51], 0 offen nt
    v_add_u32 v120, 5504, v120
    s_waitcnt vmcnt(3)
    buffer_load_dwordx4 v[24:27], v120, s[52:55], 0 offen nt
    s_waitcnt vmcnt(3)
    buffer_load_dwordx4 v[56:59], v120, s[48:51], 0 offen nt
    v_add_u32 v120, 5504, v120
    s_waitcnt vmcnt(3)
    buffer_load_dwordx4 v[28:31], v120, s[52:55], 0 offen nt
    s_waitcnt vmcnt(3)
    buffer_load_dwordx4 v[60:63], v120, s[48:51], 0 offen nt
    v_mov_b32 v96, 0
    v_mov_b32 v97, 0
    v_mov_b32 v98, 0
    v_mov_b32 v99, 0
    v_mov_b32 v100, 0
    v_mov_b32 v101, 0
    v_mov_b32 v102, 0
    v_mov_b32 v103, 0
    v_mov_b32 v104, 0
    v_mov_b32 v105, 0
    v_mov_b32 v106, 0
    v_mov_b32 v107, 0
    v_mov_b32 v108, 0
    v_mov_b32 v109, 0
    v_mov_b32 v110, 0
    v_mov_b32 v111, 0
    s_waitcnt vmcnt(0)
    v_lshrrev_b32 v117, v118, v64
    v_and_b32 v72, 0xffff, v117
    v_lshlrev_b32 v73, 16, v117
    v_lshrrev_b32 v117, v118, v65
    v_and_b32 v74, 0xffff, v117
    v_lshlrev_b32 v75, 16, v117
    v_lshrrev_b32 v117, v118, v66
    v_and_b32 v76, 0xffff, v117
    v_lshlrev_b32 v77, 16, v117
    v_lshrrev_b32 v117, v118, v67
    v_and_b32 v78, 0xffff, v117
    v_lshlrev_b32 v79, 16, v117
    v_lshrrev_b32 v117, v118, v68
    v_and_b32 v80, 0xffff, v117
    v_lshlrev_b32 v81, 16, v117
    v_lshrrev_b32 v117, v118, v69
    v_and_b32 v82, 0xffff, v117
    v_lshlrev_b32 v83, 16, v117
    v_lshrrev_b32 v117, v118, v70
    v_and_b32 v84, 0xffff, v117
    v_lshlrev_b32 v85, 16, v117
    v_lshrrev_b32 v117, v118, v71
    v_and_b32 v86, 0xffff, v117
    v_lshlrev_b32 v87, 16, v117
    v_dot2c_f32_bf16 v96, v72, v0
    v_dot2c_f32_bf16 v97, v73, v0
    v_dot2c_f32_bf16 v104, v72, v32
    v_dot2c_f32_bf16 v105, v73, v32
    v_dot2c_f32_bf16 v98, v72, v1
    v_dot2c_f32_bf16 v99, v73, v1
    v_dot2c_f32_bf16 v106, v72, v33
    v_dot2c_f32_bf16 v107, v73, v33
    v_dot2c_f32_bf16 v100, v72, v2
    v_dot2c_f32_bf16 v101, v73, v2
    v_dot2c_f32_bf16 v108, v72, v34
    v_dot2c_f32_bf16 v109, v73, v34
    v_dot2c_f32_bf16 v102, v72, v3
    v_dot2c_f32_bf16 v103, v73, v3
    v_dot2c_f32_bf16 v110, v72, v35
    v_dot2c_f32_bf16 v111, v73, v35
    v_dot2c_f32_bf16 v96, v74, v4
    v_dot2c_f32_bf16 v97, v75, v4
    v_dot2c_f32_bf16 v104, v74, v36
    v_dot2c_f32_bf16 v105, v75, v36
    v_dot2c_f32_bf16 v98, v74, v5
    v_dot2c_f32_bf16 v99, v75, v5
    v_dot2c_f32_bf16 v106, v74, v37
    v_dot2c_f32_bf16 v107, v75, v37
    v_dot2c_f32_bf16 v100, v74, v6
    v_dot2c_f32_bf16 v101, v75, v6
    v_dot2c_f32_bf16 v108, v74, v38
    v_dot2c_f32_bf16 v109, v75, v38
    v_dot2c_f32_bf16 v102, v74, v7
    v_dot2c_f32_bf16 v103, v75, v7
    v_dot2c_f32_bf16 v110, v74, v39
    v_dot2c_f32_bf16 v111, v75, v39
    v_dot2c_f32_bf16 v96, v76, v8
    v_dot2c_f32_bf16 v97, v77, v8
    v_dot2c_f32_bf16 v104, v76, v40
    v_dot2c_f32_bf16 v105, v77, v40
    v_dot2c_f32_bf16 v98, v76, v9
    v_dot2c_f32_bf16 v99, v77, v9
    v_dot2c_f32_bf16 v106, v76, v41
    v_dot2c_f32_bf16 v107, v77, v41
    v_dot2c_f32_bf16 v100, v76, v10
    v_dot2c_f32_bf16 v101, v77, v10
    v_dot2c_f32_bf16 v108, v76, v42
    v_dot2c_f32_bf16 v109, v77, v42
    v_dot2c_f32_bf16 v102, v76, v11
    v_dot2c_f32_bf16 v103, v77, v11
    v_dot2c_f32_bf16 v110, v76, v43
    v_dot2c_f32_bf16 v111, v77, v43
    v_dot2c_f32_bf16 v96, v78, v12
    v_dot2c_f32_bf16 v97, v79, v12
    v_dot2c_f32_bf16 v104, v78, v44
    v_dot2c_f32_bf16 v105, v79, v44
    v_dot2c_f32_bf16 v98, v78, v13
    v_dot2c_f32_bf16 v99, v79, v13
    v_dot2c_f32_bf16 v106, v78, v45
    v_dot2c_f32_bf16 v107, v79, v45
    v_dot2c_f32_bf16 v100, v78, v14
    v_dot2c_f32_bf16 v101, v79, v14
    v_dot2c_f32_bf16 v108, v78, v46
    v_dot2c_f32_bf16 v109, v79, v46
    v_dot2c_f32_bf16 v102, v78, v15
    v_dot2c_f32_bf16 v103, v79, v15
    v_dot2c_f32_bf16 v110, v78, v47
    v_dot2c_f32_bf16 v111, v79, v47
    v_dot2c_f32_bf16 v96, v80, v16
    v_dot2c_f32_bf16 v97, v81, v16
    v_dot2c_f32_bf16 v104, v80, v48
    v_dot2c_f32_bf16 v105, v81, v48
    v_dot2c_f32_bf16 v98, v80, v17
    v_dot2c_f32_bf16 v99, v81, v17
    v_dot2c_f32_bf16 v106, v80, v49
    v_dot2c_f32_bf16 v107, v81, v49
    v_dot2c_f32_bf16 v100, v80, v18
    v_dot2c_f32_bf16 v101, v81, v18
    v_dot2c_f32_bf16 v108, v80, v50
    v_dot2c_f32_bf16 v109, v81, v50
    v_dot2c_f32_bf16 v102, v80, v19
    v_dot2c_f32_bf16 v103, v81, v19
    v_dot2c_f32_bf16 v110, v80, v51
    v_dot2c_f32_bf16 v111, v81, v51
    v_dot2c_f32_bf16 v96, v82, v20
    v_dot2c_f32_bf16 v97, v83, v20
    v_dot2c_f32_bf16 v104, v82, v52
    v_dot2c_f32_bf16 v105, v83, v52
    v_dot2c_f32_bf16 v98, v82, v21
    v_dot2c_f32_bf16 v99, v83, v21
    v_dot2c_f32_bf16 v106, v82, v53
    v_dot2c_f32_bf16 v107, v83, v53
    v_dot2c_f32_bf16 v100, v82, v22
    v_dot2c_f32_bf16 v101, v83, v22
    v_dot2c_f32_bf16 v108, v82, v54
    v_dot2c_f32_bf16 v109, v83, v54
    v_dot2c_f32_bf16 v102, v82, v23
    v_dot2c_f32_bf16 v103, v83, v23
    v_dot2c_f32_bf16 v110, v82, v55
    v_dot2c_f32_bf16 v111, v83, v55
    v_dot2c_f32_bf16 v96, v84, v24
    v_dot2c_f32_bf16 v97, v85, v24
    v_dot2c_f32_bf16 v104, v84, v56
    v_dot2c_f32_bf16 v105, v85, v56
    v_dot2c_f32_bf16 v98, v84, v25
    v_dot2c_f32_bf16 v99, v85, v25
    v_dot2c_f32_bf16 v106, v84, v57
    v_dot2c_f32_bf16 v107, v85, v57
    v_dot2c_f32_bf16 v100, v84, v26
    v_dot2c_f32_bf16 v101, v85, v26
    v_dot2c_f32_bf16 v108, v84, v58
    v_dot2c_f32_bf16 v109, v85, v58
    v_dot2c_f32_bf16 v102, v84, v27
    v_dot2c_f32_bf16 v103, v85, v27
    v_dot2c_f32_bf16 v110, v84, v59
    v_dot2c_f32_bf16 v111, v85, v59
    v_dot2c_f32_bf16 v96, v86, v28
    v_dot2c_f32_bf16 v97, v87, v28
    v_dot2c_f32_bf16 v104, v86, v60
    v_dot2c_f32_bf16 v105, v87, v60
    v_dot2c_f32_bf16 v98, v86, v29
    v_dot2c_f32_bf16 v99, v87, v29
    v_dot2c_f32_bf16 v106, v86, v61
    v_dot2c_f32_bf16 v107, v87, v61
    v_dot2c_f32_bf16 v100, v86, v30
    v_dot2c_f32_bf16 v101, v87, v30
    v_dot2c_f32_bf16 v108, v86, v62
    v_dot2c_f32_bf16 v109, v87, v62
    v_dot2c_f32_bf16 v102, v86, v31
    v_dot2c_f32_bf16 v103, v87, v31
    v_dot2c_f32_bf16 v110, v86, v63
    v_dot2c_f32_bf16 v111, v87, v63
    v_permlane32_swap_b32 v96, v100
    v_permlane32_swap_b32 v97, v101
    v_permlane32_swap_b32 v98, v102
    v_permlane32_swap_b32 v99, v103
    v_permlane32_swap_b32 v104, v108
    v_permlane32_swap_b32 v105, v109
    v_permlane32_swap_b32 v106, v110
    v_permlane32_swap_b32 v107, v111
    v_add_f32 v96, v96, v100
    v_add_f32 v97, v97, v101
    v_add_f32 v98, v98, v102
    v_add_f32 v99, v99, v103
    v_add_f32 v104, v104, v108
    v_add_f32 v105, v105, v109
    v_add_f32 v106, v106, v110
    v_add_f32 v107, v107, v111
    v_permlane16_swap_b32 v96, v98
    v_permlane16_swap_b32 v97, v99
    v_permlane16_swap_b32 v104, v106
    v_permlane16_swap_b32 v105, v107
    v_add_f32 v96, v96, v98
    v_add_f32 v97, v97, v99
    v_add_f32 v104, v104, v106
    v_add_f32 v105, v105, v107
    v_add_f32_dpp v96, v96, v96 row_ror:8 row_mask:0xf bank_mask:0x3
    s_nop 1
    v_add_f32_dpp v96, v97, v97 row_ror:8 row_mask:0xf bank_mask:0xc
    v_add_f32_dpp v104, v104, v104 row_ror:8 row_mask:0xf bank_mask:0x3
    s_nop 1
    v_add_f32_dpp v104, v105, v105 row_ror:8 row_mask:0xf bank_mask:0xc
    s_waitcnt lgkmcnt(0)
    s_add_u32 s4, s6, 1
    s_mul_i32 s5, s4, 0x9e3779b1
    s_xor_b32 s5, s5, 0x5bd1e995
    v_mov_b32 v97, v104
    v_mov_b32 v98, s4
    v_mov_b32 v99, s5
    v_bfe_u32 v100, v125, 5, 1
    v_lshlrev_b32 v100, 2, v100
    v_bfe_u32 v101, v125, 4, 1
    v_lshl_add_u32 v100, v101, 1, v100
    v_bfe_u32 v101, v125, 3, 1
    v_add_u32 v100, v100, v101
    v_lshl_add_u32 v100, v121, 3, v100
    v_lshlrev_b32 v100, 4, v100
    s_lshl_b32 s79, s2, 10
    s_add_u32 s79, s79, 262144
    buffer_store_dwordx4 v[96:99], v100, s[60:63], s79 offen sc1
    s_nop 3
    s_branch L_wo
L_b2:
    s_cmp_lt_u32 s2, 170
    s_cbranch_scc1 L_wo
    s_sub_u32 s79, s2, 170
    s_lshl_b32 s38, s79, 14
    s_add_u32 s52, s24, s38
    s_addc_u32 s53, s25, 0
    s_mov_b32 s54, 16384
    s_mov_b32 s55, 0x20000
    v_lshlrev_b32 v102, 4, v125
    s_mov_b32 s67, 0
    buffer_load_dwordx4 v[0:3], v102, s[52:55], s67 offen nt
    s_mov_b32 s67, 1024
    buffer_load_dwordx4 v[4:7], v102, s[52:55], s67 offen nt
    s_mov_b32 s67, 2048
    buffer_load_dwordx4 v[8:11], v102, s[52:55], s67 offen nt
    s_mov_b32 s67, 3072
    buffer_load_dwordx4 v[12:15], v102, s[52:55], s67 offen nt
    s_waitcnt vmcnt(3)
    s_mov_b32 s67, 4096
    buffer_load_dwordx4 v[16:19], v102, s[52:55], s67 offen nt
    s_waitcnt vmcnt(3)
    s_mov_b32 s67, 5120
    buffer_load_dwordx4 v[20:23], v102, s[52:55], s67 offen nt
    s_waitcnt vmcnt(3)
    s_mov_b32 s67, 6144
    buffer_load_dwordx4 v[24:27], v102, s[52:55], s67 offen nt
    s_waitcnt vmcnt(3)
    s_mov_b32 s67, 7168
    buffer_load_dwordx4 v[28:31], v102, s[52:55], s67 offen nt
    s_waitcnt vmcnt(3)
    s_mov_b32 s67, 8192
    buffer_load_dwordx4 v[32:35], v102, s[52:55], s67 offen nt
    s_waitcnt vmcnt(3)
    s_mov_b32 s67, 9216
    buffer_load_dwordx4 v[36:39], v102, s[52:55], s67 offen nt
    s_waitcnt vmcnt(3)
    s_mov_b32 s67, 10240
    buffer_load_dwordx4 v[40:43], v102, s[52:55], s67 offen nt
    s_waitcnt vmcnt(3)
    s_mov_b32 s67, 11264
    buffer_load_dwordx4 v[44:47], v102, s[52:55], s67 offen nt
    s_waitcnt vmcnt(3)
    s_mov_b32 s67, 12288
    buffer_load_dwordx4 v[48:51], v102, s[52:55], s67 offen nt
    s_waitcnt vmcnt(3)
    s_mov_b32 s67, 13312
    buffer_load_dwordx4 v[52:55], v102, s[52:55], s67 offen nt
    s_waitcnt vmcnt(3)
    s_mov_b32 s67, 14336
    buffer_load_dwordx4 v[56:59], v102, s[52:55], s67 offen nt
    s_waitcnt vmcnt(3)
    s_mov_b32 s67, 15360
    buffer_load_dwordx4 v[60:63], v102, s[52:55], s67 offen nt
    v_and_b32 v114, 15, v125
    s_lshl_b32 s38, s79, 4
    v_add_u32 v114, s38, v114
    v_add_u32 v115, 1376, v114
    v_lshrrev_b32 v103, 4, v125
    v_lshlrev_b32 v103, 10, v103
    v_lshrrev_b32 v116, 6, v114
    v_lshlrev_b32 v116, 12, v116
    v_and_b32 v114, 63, v114
    v_lshl_add_u32 v116, v114, 4, v116
    v_add_u32 v116, v116, v103
    v_lshrrev_b32 v117, 6, v115
    v_lshlrev_b32 v117, 12, v117
    v_and_b32 v115, 63, v115
    v_lshl_add_u32 v117, v115, 4, v117
    v_add_u32 v117, v117, v103
    s_mov_b32 s75, 1048576
    s_nop 3
L_lw5:
    ds_read_b32 v126, v127 offset:8
    s_waitcnt lgkmcnt(0)
    v_readfirstlane_b32 s38, v126
    s_nop 1
    s_cmp_lg_u32 s38, 0
    s_nop 3
    s_cbranch_scc1 L_lwd6
    s_sub_u32 s75, s75, 1
    s_cmp_eq_u32 s75, 0
    s_cbranch_scc1 L_end
    s_sleep 8
    s_branch L_lw5
L_lwd6:
    s_mov_b32 s38, 262144
    s_add_u32 s4, s6, 1
    s_mul_i32 s5, s4, 0x9e3779b1
    s_xor_b32 s5, s5, 0x5bd1e995
    s_mov_b32 s75, 65536
L_bpoll:
    buffer_load_dwordx4 v[104:107], v116, s[60:63], s38 offen sc1
    buffer_load_dwordx4 v[108:111], v117, s[60:63], s38 offen sc1
    s_waitcnt vmcnt(0)
    v_xor_b32 v100, s4, v106
    v_xor_b32 v101, s5, v107
    v_or_b32 v100, v100, v101
    v_xor_b32 v101, s4, v110
    v_or_b32 v100, v100, v101
    v_xor_b32 v101, s5, v111
    v_or_b32 v100, v100, v101
    v_cmp_ne_u32 vcc, 0, v100
    s_nop 3
    s_nop 0
    s_cbranch_vccz L_bok
    s_sub_u32 s75, s75, 1
    s_cmp_eq_u32 s75, 0
    s_cbranch_scc1 L_end
    s_sleep 8
    s_branch L_bpoll
L_bok:
    v_add_f32 v112, v104, v108
    v_add_f32 v113, v105, v109
    v_mov_b32 v100, v112
    s_nop 1
    v_permlane16_swap_b32 v112, v100
    v_add_f32 v112, v112, v100
    v_mov_b32 v100, v112
    s_nop 1
    v_permlane32_swap_b32 v112, v100
    v_add_f32 v112, v112, v100
    v_mov_b32 v100, v113
    s_nop 1
    v_permlane16_swap_b32 v113, v100
    v_add_f32 v113, v113, v100
    v_mov_b32 v100, v113
    s_nop 1
    v_permlane32_swap_b32 v113, v100
    v_add_f32 v113, v113, v100
    v_cvt_pk_bf16_f32 v112, 0, v112
    v_cvt_pk_bf16_f32 v113, 0, v113
    v_mul_f32 v114, v112, v113
    v_cvt_pk_bf16_f32 v112, v114, 0
    v_cvt_pk_bf16_f32 v113, 0, v114
    v_mov_b32 v96, 0
    v_mov_b32 v97, 0
    v_mov_b32 v98, 0
    v_mov_b32 v99, 0
    v_mov_b32 v100, 0
    v_mov_b32 v101, 0
    v_mov_b32 v102, 0
    v_mov_b32 v103, 0
    v_dot2c_f32_bf16_dpp v96, v112, v0 row_newbcast:0 row_mask:0xf bank_mask:0xf
    v_dot2c_f32_bf16_dpp v97, v113, v0 row_newbcast:0 row_mask:0xf bank_mask:0xf
    v_dot2c_f32_bf16_dpp v98, v112, v1 row_newbcast:0 row_mask:0xf bank_mask:0xf
    v_dot2c_f32_bf16_dpp v99, v113, v1 row_newbcast:0 row_mask:0xf bank_mask:0xf
    v_dot2c_f32_bf16_dpp v100, v112, v2 row_newbcast:0 row_mask:0xf bank_mask:0xf
    v_dot2c_f32_bf16_dpp v101, v113, v2 row_newbcast:0 row_mask:0xf bank_mask:0xf
    v_dot2c_f32_bf16_dpp v102, v112, v3 row_newbcast:0 row_mask:0xf bank_mask:0xf
    v_dot2c_f32_bf16_dpp v103, v113, v3 row_newbcast:0 row_mask:0xf bank_mask:0xf
    v_dot2c_f32_bf16_dpp v96, v112, v4 row_newbcast:1 row_mask:0xf bank_mask:0xf
    v_dot2c_f32_bf16_dpp v97, v113, v4 row_newbcast:1 row_mask:0xf bank_mask:0xf
    v_dot2c_f32_bf16_dpp v98, v112, v5 row_newbcast:1 row_mask:0xf bank_mask:0xf
    v_dot2c_f32_bf16_dpp v99, v113, v5 row_newbcast:1 row_mask:0xf bank_mask:0xf
    v_dot2c_f32_bf16_dpp v100, v112, v6 row_newbcast:1 row_mask:0xf bank_mask:0xf
    v_dot2c_f32_bf16_dpp v101, v113, v6 row_newbcast:1 row_mask:0xf bank_mask:0xf
    v_dot2c_f32_bf16_dpp v102, v112, v7 row_newbcast:1 row_mask:0xf bank_mask:0xf
    v_dot2c_f32_bf16_dpp v103, v113, v7 row_newbcast:1 row_mask:0xf bank_mask:0xf
    v_dot2c_f32_bf16_dpp v96, v112, v8 row_newbcast:2 row_mask:0xf bank_mask:0xf
    v_dot2c_f32_bf16_dpp v97, v113, v8 row_newbcast:2 row_mask:0xf bank_mask:0xf
    v_dot2c_f32_bf16_dpp v98, v112, v9 row_newbcast:2 row_mask:0xf bank_mask:0xf
    v_dot2c_f32_bf16_dpp v99, v113, v9 row_newbcast:2 row_mask:0xf bank_mask:0xf
    v_dot2c_f32_bf16_dpp v100, v112, v10 row_newbcast:2 row_mask:0xf bank_mask:0xf
    v_dot2c_f32_bf16_dpp v101, v113, v10 row_newbcast:2 row_mask:0xf bank_mask:0xf
    v_dot2c_f32_bf16_dpp v102, v112, v11 row_newbcast:2 row_mask:0xf bank_mask:0xf
    v_dot2c_f32_bf16_dpp v103, v113, v11 row_newbcast:2 row_mask:0xf bank_mask:0xf
    v_dot2c_f32_bf16_dpp v96, v112, v12 row_newbcast:3 row_mask:0xf bank_mask:0xf
    v_dot2c_f32_bf16_dpp v97, v113, v12 row_newbcast:3 row_mask:0xf bank_mask:0xf
    v_dot2c_f32_bf16_dpp v98, v112, v13 row_newbcast:3 row_mask:0xf bank_mask:0xf
    v_dot2c_f32_bf16_dpp v99, v113, v13 row_newbcast:3 row_mask:0xf bank_mask:0xf
    v_dot2c_f32_bf16_dpp v100, v112, v14 row_newbcast:3 row_mask:0xf bank_mask:0xf
    v_dot2c_f32_bf16_dpp v101, v113, v14 row_newbcast:3 row_mask:0xf bank_mask:0xf
    v_dot2c_f32_bf16_dpp v102, v112, v15 row_newbcast:3 row_mask:0xf bank_mask:0xf
    v_dot2c_f32_bf16_dpp v103, v113, v15 row_newbcast:3 row_mask:0xf bank_mask:0xf
    v_dot2c_f32_bf16_dpp v96, v112, v16 row_newbcast:4 row_mask:0xf bank_mask:0xf
    v_dot2c_f32_bf16_dpp v97, v113, v16 row_newbcast:4 row_mask:0xf bank_mask:0xf
    v_dot2c_f32_bf16_dpp v98, v112, v17 row_newbcast:4 row_mask:0xf bank_mask:0xf
    v_dot2c_f32_bf16_dpp v99, v113, v17 row_newbcast:4 row_mask:0xf bank_mask:0xf
    v_dot2c_f32_bf16_dpp v100, v112, v18 row_newbcast:4 row_mask:0xf bank_mask:0xf
    v_dot2c_f32_bf16_dpp v101, v113, v18 row_newbcast:4 row_mask:0xf bank_mask:0xf
    v_dot2c_f32_bf16_dpp v102, v112, v19 row_newbcast:4 row_mask:0xf bank_mask:0xf
    v_dot2c_f32_bf16_dpp v103, v113, v19 row_newbcast:4 row_mask:0xf bank_mask:0xf
    v_dot2c_f32_bf16_dpp v96, v112, v20 row_newbcast:5 row_mask:0xf bank_mask:0xf
    v_dot2c_f32_bf16_dpp v97, v113, v20 row_newbcast:5 row_mask:0xf bank_mask:0xf
    v_dot2c_f32_bf16_dpp v98, v112, v21 row_newbcast:5 row_mask:0xf bank_mask:0xf
    v_dot2c_f32_bf16_dpp v99, v113, v21 row_newbcast:5 row_mask:0xf bank_mask:0xf
    v_dot2c_f32_bf16_dpp v100, v112, v22 row_newbcast:5 row_mask:0xf bank_mask:0xf
    v_dot2c_f32_bf16_dpp v101, v113, v22 row_newbcast:5 row_mask:0xf bank_mask:0xf
    v_dot2c_f32_bf16_dpp v102, v112, v23 row_newbcast:5 row_mask:0xf bank_mask:0xf
    v_dot2c_f32_bf16_dpp v103, v113, v23 row_newbcast:5 row_mask:0xf bank_mask:0xf
    v_dot2c_f32_bf16_dpp v96, v112, v24 row_newbcast:6 row_mask:0xf bank_mask:0xf
    v_dot2c_f32_bf16_dpp v97, v113, v24 row_newbcast:6 row_mask:0xf bank_mask:0xf
    v_dot2c_f32_bf16_dpp v98, v112, v25 row_newbcast:6 row_mask:0xf bank_mask:0xf
    v_dot2c_f32_bf16_dpp v99, v113, v25 row_newbcast:6 row_mask:0xf bank_mask:0xf
    v_dot2c_f32_bf16_dpp v100, v112, v26 row_newbcast:6 row_mask:0xf bank_mask:0xf
    v_dot2c_f32_bf16_dpp v101, v113, v26 row_newbcast:6 row_mask:0xf bank_mask:0xf
    v_dot2c_f32_bf16_dpp v102, v112, v27 row_newbcast:6 row_mask:0xf bank_mask:0xf
    v_dot2c_f32_bf16_dpp v103, v113, v27 row_newbcast:6 row_mask:0xf bank_mask:0xf
    v_dot2c_f32_bf16_dpp v96, v112, v28 row_newbcast:7 row_mask:0xf bank_mask:0xf
    v_dot2c_f32_bf16_dpp v97, v113, v28 row_newbcast:7 row_mask:0xf bank_mask:0xf
    v_dot2c_f32_bf16_dpp v98, v112, v29 row_newbcast:7 row_mask:0xf bank_mask:0xf
    v_dot2c_f32_bf16_dpp v99, v113, v29 row_newbcast:7 row_mask:0xf bank_mask:0xf
    v_dot2c_f32_bf16_dpp v100, v112, v30 row_newbcast:7 row_mask:0xf bank_mask:0xf
    v_dot2c_f32_bf16_dpp v101, v113, v30 row_newbcast:7 row_mask:0xf bank_mask:0xf
    v_dot2c_f32_bf16_dpp v102, v112, v31 row_newbcast:7 row_mask:0xf bank_mask:0xf
    v_dot2c_f32_bf16_dpp v103, v113, v31 row_newbcast:7 row_mask:0xf bank_mask:0xf
    v_dot2c_f32_bf16_dpp v96, v112, v32 row_newbcast:8 row_mask:0xf bank_mask:0xf
    v_dot2c_f32_bf16_dpp v97, v113, v32 row_newbcast:8 row_mask:0xf bank_mask:0xf
    v_dot2c_f32_bf16_dpp v98, v112, v33 row_newbcast:8 row_mask:0xf bank_mask:0xf
    v_dot2c_f32_bf16_dpp v99, v113, v33 row_newbcast:8 row_mask:0xf bank_mask:0xf
    v_dot2c_f32_bf16_dpp v100, v112, v34 row_newbcast:8 row_mask:0xf bank_mask:0xf
    v_dot2c_f32_bf16_dpp v101, v113, v34 row_newbcast:8 row_mask:0xf bank_mask:0xf
    v_dot2c_f32_bf16_dpp v102, v112, v35 row_newbcast:8 row_mask:0xf bank_mask:0xf
    v_dot2c_f32_bf16_dpp v103, v113, v35 row_newbcast:8 row_mask:0xf bank_mask:0xf
    v_dot2c_f32_bf16_dpp v96, v112, v36 row_newbcast:9 row_mask:0xf bank_mask:0xf
    v_dot2c_f32_bf16_dpp v97, v113, v36 row_newbcast:9 row_mask:0xf bank_mask:0xf
    v_dot2c_f32_bf16_dpp v98, v112, v37 row_newbcast:9 row_mask:0xf bank_mask:0xf
    v_dot2c_f32_bf16_dpp v99, v113, v37 row_newbcast:9 row_mask:0xf bank_mask:0xf
    v_dot2c_f32_bf16_dpp v100, v112, v38 row_newbcast:9 row_mask:0xf bank_mask:0xf
    v_dot2c_f32_bf16_dpp v101, v113, v38 row_newbcast:9 row_mask:0xf bank_mask:0xf
    v_dot2c_f32_bf16_dpp v102, v112, v39 row_newbcast:9 row_mask:0xf bank_mask:0xf
    v_dot2c_f32_bf16_dpp v103, v113, v39 row_newbcast:9 row_mask:0xf bank_mask:0xf
    v_dot2c_f32_bf16_dpp v96, v112, v40 row_newbcast:10 row_mask:0xf bank_mask:0xf
    v_dot2c_f32_bf16_dpp v97, v113, v40 row_newbcast:10 row_mask:0xf bank_mask:0xf
    v_dot2c_f32_bf16_dpp v98, v112, v41 row_newbcast:10 row_mask:0xf bank_mask:0xf
    v_dot2c_f32_bf16_dpp v99, v113, v41 row_newbcast:10 row_mask:0xf bank_mask:0xf
    v_dot2c_f32_bf16_dpp v100, v112, v42 row_newbcast:10 row_mask:0xf bank_mask:0xf
    v_dot2c_f32_bf16_dpp v101, v113, v42 row_newbcast:10 row_mask:0xf bank_mask:0xf
    v_dot2c_f32_bf16_dpp v102, v112, v43 row_newbcast:10 row_mask:0xf bank_mask:0xf
    v_dot2c_f32_bf16_dpp v103, v113, v43 row_newbcast:10 row_mask:0xf bank_mask:0xf
    v_dot2c_f32_bf16_dpp v96, v112, v44 row_newbcast:11 row_mask:0xf bank_mask:0xf
    v_dot2c_f32_bf16_dpp v97, v113, v44 row_newbcast:11 row_mask:0xf bank_mask:0xf
    v_dot2c_f32_bf16_dpp v98, v112, v45 row_newbcast:11 row_mask:0xf bank_mask:0xf
    v_dot2c_f32_bf16_dpp v99, v113, v45 row_newbcast:11 row_mask:0xf bank_mask:0xf
    v_dot2c_f32_bf16_dpp v100, v112, v46 row_newbcast:11 row_mask:0xf bank_mask:0xf
    v_dot2c_f32_bf16_dpp v101, v113, v46 row_newbcast:11 row_mask:0xf bank_mask:0xf
    v_dot2c_f32_bf16_dpp v102, v112, v47 row_newbcast:11 row_mask:0xf bank_mask:0xf
    v_dot2c_f32_bf16_dpp v103, v113, v47 row_newbcast:11 row_mask:0xf bank_mask:0xf
    v_dot2c_f32_bf16_dpp v96, v112, v48 row_newbcast:12 row_mask:0xf bank_mask:0xf
    v_dot2c_f32_bf16_dpp v97, v113, v48 row_newbcast:12 row_mask:0xf bank_mask:0xf
    v_dot2c_f32_bf16_dpp v98, v112, v49 row_newbcast:12 row_mask:0xf bank_mask:0xf
    v_dot2c_f32_bf16_dpp v99, v113, v49 row_newbcast:12 row_mask:0xf bank_mask:0xf
    v_dot2c_f32_bf16_dpp v100, v112, v50 row_newbcast:12 row_mask:0xf bank_mask:0xf
    v_dot2c_f32_bf16_dpp v101, v113, v50 row_newbcast:12 row_mask:0xf bank_mask:0xf
    v_dot2c_f32_bf16_dpp v102, v112, v51 row_newbcast:12 row_mask:0xf bank_mask:0xf
    v_dot2c_f32_bf16_dpp v103, v113, v51 row_newbcast:12 row_mask:0xf bank_mask:0xf
    v_dot2c_f32_bf16_dpp v96, v112, v52 row_newbcast:13 row_mask:0xf bank_mask:0xf
    v_dot2c_f32_bf16_dpp v97, v113, v52 row_newbcast:13 row_mask:0xf bank_mask:0xf
    v_dot2c_f32_bf16_dpp v98, v112, v53 row_newbcast:13 row_mask:0xf bank_mask:0xf
    v_dot2c_f32_bf16_dpp v99, v113, v53 row_newbcast:13 row_mask:0xf bank_mask:0xf
    v_dot2c_f32_bf16_dpp v100, v112, v54 row_newbcast:13 row_mask:0xf bank_mask:0xf
    v_dot2c_f32_bf16_dpp v101, v113, v54 row_newbcast:13 row_mask:0xf bank_mask:0xf
    v_dot2c_f32_bf16_dpp v102, v112, v55 row_newbcast:13 row_mask:0xf bank_mask:0xf
    v_dot2c_f32_bf16_dpp v103, v113, v55 row_newbcast:13 row_mask:0xf bank_mask:0xf
    v_dot2c_f32_bf16_dpp v96, v112, v56 row_newbcast:14 row_mask:0xf bank_mask:0xf
    v_dot2c_f32_bf16_dpp v97, v113, v56 row_newbcast:14 row_mask:0xf bank_mask:0xf
    v_dot2c_f32_bf16_dpp v98, v112, v57 row_newbcast:14 row_mask:0xf bank_mask:0xf
    v_dot2c_f32_bf16_dpp v99, v113, v57 row_newbcast:14 row_mask:0xf bank_mask:0xf
    v_dot2c_f32_bf16_dpp v100, v112, v58 row_newbcast:14 row_mask:0xf bank_mask:0xf
    v_dot2c_f32_bf16_dpp v101, v113, v58 row_newbcast:14 row_mask:0xf bank_mask:0xf
    v_dot2c_f32_bf16_dpp v102, v112, v59 row_newbcast:14 row_mask:0xf bank_mask:0xf
    v_dot2c_f32_bf16_dpp v103, v113, v59 row_newbcast:14 row_mask:0xf bank_mask:0xf
    v_dot2c_f32_bf16_dpp v96, v112, v60 row_newbcast:15 row_mask:0xf bank_mask:0xf
    v_dot2c_f32_bf16_dpp v97, v113, v60 row_newbcast:15 row_mask:0xf bank_mask:0xf
    v_dot2c_f32_bf16_dpp v98, v112, v61 row_newbcast:15 row_mask:0xf bank_mask:0xf
    v_dot2c_f32_bf16_dpp v99, v113, v61 row_newbcast:15 row_mask:0xf bank_mask:0xf
    v_dot2c_f32_bf16_dpp v100, v112, v62 row_newbcast:15 row_mask:0xf bank_mask:0xf
    v_dot2c_f32_bf16_dpp v101, v113, v62 row_newbcast:15 row_mask:0xf bank_mask:0xf
    v_dot2c_f32_bf16_dpp v102, v112, v63 row_newbcast:15 row_mask:0xf bank_mask:0xf
    v_dot2c_f32_bf16_dpp v103, v113, v63 row_newbcast:15 row_mask:0xf bank_mask:0xf
    v_lshlrev_b32 v114, 5, v125
    ds_write_b128 v114, v[96:99] offset:6400
    s_nop 0
    ds_write_b128 v114, v[100:103] offset:6416
    v_lshlrev_b32 v114, 3, v125
    s_waitcnt lgkmcnt(0)
    ds_read_b64 v[96:97], v114 offset:6400
    ds_read_b64 v[100:101], v114 offset:6912
    ds_read_b64 v[104:105], v114 offset:7424
    ds_read_b64 v[108:109], v114 offset:7936
    v_mov_b32 v98, s4
    v_mov_b32 v99, s5
    v_mov_b32 v102, s4
    v_mov_b32 v103, s5
    v_mov_b32 v106, s4
    v_mov_b32 v107, s5
    v_mov_b32 v110, s4
    v_mov_b32 v111, s5
    v_lshrrev_b32 v114, 3, v125
    v_lshlrev_b32 v114, 14, v114
    v_and_b32 v115, 7, v125
    v_lshl_add_u32 v114, v115, 4, v114
    s_lshl_b32 s38, s79, 7
    s_add_u32 s38, s38, 524288
    s_waitcnt lgkmcnt(0)
    buffer_store_dwordx4 v[96:99], v114, s[60:63], s38 offen sc1
    s_add_u32 s38, s38, 0x20000
    buffer_store_dwordx4 v[100:103], v114, s[60:63], s38 offen sc1
    s_add_u32 s38, s38, 0x20000
    buffer_store_dwordx4 v[104:107], v114, s[60:63], s38 offen sc1
    s_add_u32 s38, s38, 0x20000
    buffer_store_dwordx4 v[108:111], v114, s[60:63], s38 offen sc1
    s_nop 3
    s_branch L_wo
L_gate:
    s_cmp_ge_u32 s2, 32
    s_cbranch_scc1 L_wo
    v_lshlrev_b32 v102, 4, v125
    global_load_dwordx4 v[8:11], v102, s[8:9]
    global_load_dwordx4 v[12:15], v102, s[26:27]
    v_mov_b32 v16, 0
    s_mov_b32 s38, 0x3f803f80
    s_waitcnt vmcnt(0)
    v_lshlrev_b32 v17, 16, v8
    v_lshlrev_b32 v18, 16, v12
    v_and_b32 v19, 0xffff0000, v8
    v_and_b32 v20, 0xffff0000, v12
    v_mul_f32 v17, v17, v18
    v_mul_f32 v19, v19, v20
    v_cvt_pk_bf16_f32 v17, v17, v19
    v_dot2c_f32_bf16 v16, s38, v17
    v_lshlrev_b32 v17, 16, v9
    v_lshlrev_b32 v18, 16, v13
    v_and_b32 v19, 0xffff0000, v9
    v_and_b32 v20, 0xffff0000, v13
    v_mul_f32 v17, v17, v18
    v_mul_f32 v19, v19, v20
    v_cvt_pk_bf16_f32 v17, v17, v19
    v_dot2c_f32_bf16 v16, s38, v17
    v_lshlrev_b32 v17, 16, v10
    v_lshlrev_b32 v18, 16, v14
    v_and_b32 v19, 0xffff0000, v10
    v_and_b32 v20, 0xffff0000, v14
    v_mul_f32 v17, v17, v18
    v_mul_f32 v19, v19, v20
    v_cvt_pk_bf16_f32 v17, v17, v19
    v_dot2c_f32_bf16 v16, s38, v17
    v_lshlrev_b32 v17, 16, v11
    v_lshlrev_b32 v18, 16, v15
    v_and_b32 v19, 0xffff0000, v11
    v_and_b32 v20, 0xffff0000, v15
    v_mul_f32 v17, v17, v18
    v_mul_f32 v19, v19, v20
    v_cvt_pk_bf16_f32 v17, v17, v19
    v_dot2c_f32_bf16 v16, s38, v17
    s_nop 2
    v_add_f32_dpp v16, v16, v16 row_ror:8 row_mask:0xf bank_mask:0xf
    s_nop 1
    v_add_f32_dpp v16, v16, v16 row_ror:4 row_mask:0xf bank_mask:0xf
    s_nop 1
    v_add_f32_dpp v16, v16, v16 row_ror:2 row_mask:0xf bank_mask:0xf
    s_nop 1
    v_add_f32_dpp v16, v16, v16 row_ror:1 row_mask:0xf bank_mask:0xf
    s_nop 1
    v_add_f32_dpp v16, v16, v16 row_bcast:15 row_mask:0xa bank_mask:0xf
    s_nop 1
    v_add_f32_dpp v16, v16, v16 row_bcast:31 row_mask:0xc bank_mask:0xf
    s_nop 0
    v_readlane_b32 s38, v16, 63
    s_nop 1
    v_mov_b32 v16, s38
    v_cvt_pk_bf16_f32 v16, 0, v16
    v_mul_f32 v16, 0xbfb8aa3b, v16
    v_exp_f32 v16, v16
    s_nop 0
    v_add_f32 v16, 1.0, v16
    v_rcp_f32 v16, v16
    s_nop 0
    v_cvt_pk_bf16_f32 v16, 0, v16
    v_sub_f32 v17, 1.0, v16
    v_cvt_pk_bf16_f32 v17, 0, v17
    s_mov_b64 exec, 1
    ds_write_b64 v127, v[16:17] offset:832
    s_mov_b64 exec, -1
    s_nop 3
L_wo:
    s_mov_b32 s75, 1048576
L_lw7:
    ds_read_b32 v126, v127 offset:8
    s_waitcnt lgkmcnt(0)
    v_readfirstlane_b32 s38, v126
    s_nop 1
    s_cmp_lg_u32 s38, 0
    s_nop 3
    s_cbranch_scc1 L_lwd8
    s_sub_u32 s75, s75, 1
    s_cmp_eq_u32 s75, 0
    s_cbranch_scc1 L_end
    s_sleep 8
    s_branch L_lw7
L_lwd8:
L_wo2:
    s_lshl_b32 s38, s35, 17
    s_add_u32 s48, s16, s38
    s_addc_u32 s49, s17, 0
    s_mov_b32 s50, 0x20000
    s_mov_b32 s51, 0x20000
    s_mov_b32 s76, 0x05040100
    s_mov_b32 s77, 0x07060302
    v_lshrrev_b32 v122, 3, v125
    v_and_b32 v121, 7, v125
    v_lshlrev_b32 v120, 14, v122
    v_lshl_add_u32 v120, v121, 4, v120
    s_sub_u32 s74, s34, 8
    s_lshl_b32 s38, s74, 7
    v_add_u32 v120, s38, v120
    s_mov_b32 s67, 0
    buffer_load_dwordx4 v[0:3], v120, s[48:51], s67 offen nt
    s_mov_b32 s67, 1024
    buffer_load_dwordx4 v[4:7], v120, s[48:51], s67 offen nt
    s_waitcnt vmcnt(1)
    s_mov_b32 s67, 2048
    buffer_load_dwordx4 v[8:11], v120, s[48:51], s67 offen nt
    s_waitcnt vmcnt(1)
    s_mov_b32 s67, 3072
    buffer_load_dwordx4 v[12:15], v120, s[48:51], s67 offen nt
    s_waitcnt vmcnt(1)
    s_mov_b32 s67, 4096
    buffer_load_dwordx4 v[16:19], v120, s[48:51], s67 offen nt
    s_waitcnt vmcnt(1)
    s_mov_b32 s67, 5120
    buffer_load_dwordx4 v[20:23], v120, s[48:51], s67 offen nt
    s_waitcnt vmcnt(1)
    s_mov_b32 s67, 6144
    buffer_load_dwordx4 v[24:27], v120, s[48:51], s67 offen nt
    s_waitcnt vmcnt(1)
    s_mov_b32 s67, 7168
    buffer_load_dwordx4 v[28:31], v120, s[48:51], s67 offen nt
    s_waitcnt vmcnt(1)
    s_mov_b32 s67, 8192
    buffer_load_dwordx4 v[32:35], v120, s[48:51], s67 offen nt
    s_waitcnt vmcnt(1)
    s_mov_b32 s67, 9216
    buffer_load_dwordx4 v[36:39], v120, s[48:51], s67 offen nt
    s_waitcnt vmcnt(1)
    s_mov_b32 s67, 10240
    buffer_load_dwordx4 v[40:43], v120, s[48:51], s67 offen nt
    s_waitcnt vmcnt(1)
    s_mov_b32 s67, 11264
    buffer_load_dwordx4 v[44:47], v120, s[48:51], s67 offen nt
    s_waitcnt vmcnt(1)
    s_mov_b32 s67, 12288
    buffer_load_dwordx4 v[48:51], v120, s[48:51], s67 offen nt
    s_waitcnt vmcnt(1)
    s_mov_b32 s67, 13312
    buffer_load_dwordx4 v[52:55], v120, s[48:51], s67 offen nt
    s_waitcnt vmcnt(1)
    s_mov_b32 s67, 14336
    buffer_load_dwordx4 v[56:59], v120, s[48:51], s67 offen nt
    s_waitcnt vmcnt(1)
    s_mov_b32 s67, 15360
    buffer_load_dwordx4 v[60:63], v120, s[48:51], s67 offen nt
    v_lshlrev_b32 v105, 5, v122
    v_lshlrev_b32 v93, 6, v122
    v_bfe_u32 v100, v125, 5, 1
    v_lshlrev_b32 v100, 1, v100
    v_bfe_u32 v101, v125, 4, 1
    v_add_u32 v100, v100, v101
    v_lshl_add_u32 v100, v121, 2, v100
    v_lshrrev_b32 v101, 3, v100
    v_lshlrev_b32 v101, 15, v101
    v_and_b32 v100, 7, v100
    v_lshl_add_u32 v92, v100, 4, v101
    v_bfe_u32 v101, v125, 3, 1
    v_lshl_or_b32 v92, v101, 31, v92
    s_lshl_b32 s38, s74, 17
    s_lshl_b32 s79, s37, 7
    s_add_u32 s79, s79, s38
    s_add_u32 s79, s79, 1048576
    s_waitcnt lgkmcnt(0)
    s_add_u32 s4, s6, 1
    s_mul_i32 s5, s4, 0x9e3779b1
    s_xor_b32 s5, s5, 0x5bd1e995
    v_mov_b32 v90, s4
    v_mov_b32 v91, s5
    v_perm_b32 v64, v4, v0, s76
    v_perm_b32 v65, v5, v1, s76
    v_perm_b32 v66, v6, v2, s76
    v_perm_b32 v67, v7, v3, s76
    v_perm_b32 v4, v4, v0, s77
    v_perm_b32 v5, v5, v1, s77
    v_perm_b32 v6, v6, v2, s77
    v_perm_b32 v7, v7, v3, s77
    v_perm_b32 v0, v12, v8, s76
    v_perm_b32 v1, v13, v9, s76
    v_perm_b32 v2, v14, v10, s76
    v_perm_b32 v3, v15, v11, s76
    v_perm_b32 v12, v12, v8, s77
    v_perm_b32 v13, v13, v9, s77
    v_perm_b32 v14, v14, v10, s77
    v_perm_b32 v15, v15, v11, s77
    v_perm_b32 v8, v20, v16, s76
    v_perm_b32 v9, v21, v17, s76
    v_perm_b32 v10, v22, v18, s76
    v_perm_b32 v11, v23, v19, s76
    v_perm_b32 v20, v20, v16, s77
    v_perm_b32 v21, v21, v17, s77
    v_perm_b32 v22, v22, v18, s77
    v_perm_b32 v23, v23, v19, s77
    v_perm_b32 v16, v28, v24, s76
    v_perm_b32 v17, v29, v25, s76
    v_perm_b32 v18, v30, v26, s76
    v_perm_b32 v19, v31, v27, s76
    v_perm_b32 v28, v28, v24, s77
    v_perm_b32 v29, v29, v25, s77
    v_perm_b32 v30, v30, v26, s77
    v_perm_b32 v31, v31, v27, s77
    v_perm_b32 v24, v36, v32, s76
    v_perm_b32 v25, v37, v33, s76
    v_perm_b32 v26, v38, v34, s76
    v_perm_b32 v27, v39, v35, s76
    v_perm_b32 v36, v36, v32, s77
    v_perm_b32 v37, v37, v33, s77
    v_perm_b32 v38, v38, v34, s77
    v_perm_b32 v39, v39, v35, s77
    v_perm_b32 v32, v44, v40, s76
    v_perm_b32 v33, v45, v41, s76
    v_perm_b32 v34, v46, v42, s76
    v_perm_b32 v35, v47, v43, s76
    v_perm_b32 v44, v44, v40, s77
    v_perm_b32 v45, v45, v41, s77
    v_perm_b32 v46, v46, v42, s77
    v_perm_b32 v47, v47, v43, s77
    v_perm_b32 v40, v52, v48, s76
    v_perm_b32 v41, v53, v49, s76
    v_perm_b32 v42, v54, v50, s76
    v_perm_b32 v43, v55, v51, s76
    v_perm_b32 v52, v52, v48, s77
    v_perm_b32 v53, v53, v49, s77
    v_perm_b32 v54, v54, v50, s77
    v_perm_b32 v55, v55, v51, s77
    s_waitcnt vmcnt(0)
    v_perm_b32 v48, v60, v56, s76
    v_perm_b32 v49, v61, v57, s76
    v_perm_b32 v50, v62, v58, s76
    v_perm_b32 v51, v63, v59, s76
    v_perm_b32 v60, v60, v56, s77
    v_perm_b32 v61, v61, v57, s77
    v_perm_b32 v62, v62, v58, s77
    v_perm_b32 v63, v63, v59, s77
    v_mov_b32 v80, 0
    v_mov_b32 v81, 0
    v_mov_b32 v82, 0
    v_mov_b32 v83, 0
    v_mov_b32 v84, 0
    v_mov_b32 v85, 0
    v_mov_b32 v86, 0
    v_mov_b32 v87, 0
    s_cmp_lg_u32 s34, 12
    s_nop 3
    s_cbranch_scc1 L_barA
    s_mov_b32 s75, 1048576
L_lw9:
    ds_read_b32 v126, v127 offset:16
    s_waitcnt lgkmcnt(0)
    v_readfirstlane_b32 s38, v126
    s_nop 1
    s_cmp_ge_u32 s38, 8
    s_nop 3
    s_cbranch_scc1 L_lwd10
    s_sub_u32 s75, s75, 1
    s_cmp_eq_u32 s75, 0
    s_cbranch_scc1 L_end
    s_sleep 2
    s_branch L_lw9
L_lwd10:
    v_and_b32 v99, 7, v125
    v_lshlrev_b32 v99, 2, v99
    ds_read_b32 v96, v99 offset:64
    ds_read_b32 v97, v99 offset:128
    v_mov_b32 v98, s4
    v_mov_b32 v99, s5
    s_waitcnt lgkmcnt(0)
    v_max_f32_dpp v96, v96, v96 quad_perm:[1,0,3,2] row_mask:0xf bank_mask:0xf
    v_add_f32_dpp v97, v97, v97 quad_perm:[1,0,3,2] row_mask:0xf bank_mask:0xf
    s_nop 0
    v_max_f32_dpp v96, v96, v96 quad_perm:[2,3,0,1] row_mask:0xf bank_mask:0xf
    v_add_f32_dpp v97, v97, v97 quad_perm:[2,3,0,1] row_mask:0xf bank_mask:0xf
    s_nop 0
    v_max_f32_dpp v96, v96, v96 row_half_mirror row_mask:0xf bank_mask:0xf
    v_add_f32_dpp v97, v97, v97 row_half_mirror row_mask:0xf bank_mask:0xf
    s_lshl_b32 s38, s37, 4
    s_add_u32 s38, s38, 458752
    s_mov_b64 exec, 1
    buffer_store_dwordx4 v[96:99], v127, s[60:63], s38 offen sc1
    s_mov_b64 exec, -1
    s_nop 3
    s_branch L_barA
.section .rodata,"a"
.p2align 6
.amdhsa_kernel gated_mix__mha_block_cached__glu_gated_bilinear__decode_kernel
  .amdhsa_next_free_vgpr 128
  .amdhsa_next_free_sgpr 80
  .amdhsa_accum_offset 128
  .amdhsa_group_segment_fixed_size 0
  .amdhsa_kernarg_size 104
  .amdhsa_user_sgpr_count 2
  .amdhsa_user_sgpr_kernarg_segment_ptr 1
  .amdhsa_system_sgpr_workgroup_id_x 1
.end_amdhsa_kernel
.text
```
